```python
import torch

def _softmax(x, axis=-1):
    return torch.softmax(x, dim=axis)

def _gelu(x):
    return torch.nn.functional.gelu(x, approximate='tanh')

def _silu(x):
    return torch.nn.functional.silu(x)

def _sigmoid(x):
    return torch.sigmoid(x)

def _layernorm(x, axis=-1, eps=1e-05):
    m = x.mean(dim=axis, keepdim=True)
    v = x.var(dim=axis, keepdim=True, unbiased=False)
    return (x - m) / torch.sqrt(v + eps)

def _scatter_add(tgt, idx, src, axis=0):
    return tgt.clone().index_add_(axis, idx, src)

def _segment_sum(src, seg, n):
    out = torch.zeros((n,) + src.shape[1:], dtype=src.dtype)
    return out.index_add_(0, seg, src)

def _pad(x, pw):
    flat = tuple((v for pair in reversed(pw) for v in pair))
    return torch.nn.functional.pad(x, flat)
kernel_name = 'adaLN_cond__linear_kernel_hedgehog__glu_gated_geglu__prompt'

def setup_inputs():

    _w = lambda a: (lambda t: t.to(torch.bfloat16) if t.is_floating_point() else t)(torch.as_tensor(a))

    def _A_setup():
        B, S, D, H = (1, 2048, 512, 32)
        Dh = D // H
        return {'x': _w((lambda *s: torch.randn(*s, dtype=torch.bfloat16) * 0.1)(B, S, D)), 'wqkv': _w((lambda *s: torch.randn(*s, dtype=torch.bfloat16) * 0.2)(D, 3 * D)), 'w_phi': _w((lambda *s: torch.randn(*s, dtype=torch.bfloat16) * 0.2)(H, Dh, Dh) * Dh ** (-0.5)), 'wo': _w((lambda *s: torch.randn(*s, dtype=torch.bfloat16) * 0.2)(D, D))}
    _A_in = _A_setup()

    def _B_setup():
        B, S, Dm, Df = (1, 2048, 512, 1376)
        return {'x': _w((lambda *s: torch.randn(*s, dtype=torch.bfloat16) * 0.1)(B, S, Dm)), 'w_gate': _w((lambda *s: torch.randn(*s, dtype=torch.bfloat16) * 3.2)(Dm, Df) * Dm ** (-0.5)), 'w_up': _w((lambda *s: torch.randn(*s, dtype=torch.bfloat16) * 3.2)(Dm, Df) * Dm ** (-0.5)), 'w_down': _w((lambda *s: torch.randn(*s, dtype=torch.bfloat16) * 3.2)(Df, Dm) * Df ** (-0.5))}
    _B_in = _B_setup()
    return {'A_x': _A_in['x'], 'A_wqkv': _A_in['wqkv'], 'A_w_phi': _A_in['w_phi'], 'A_wo': _A_in['wo'], 'B_x': _B_in['x'], 'B_w_gate': _B_in['w_gate'], 'B_w_up': _B_in['w_up'], 'B_w_down': _B_in['w_down'], 'c': _w((lambda *s: torch.randn(*s, dtype=torch.bfloat16) * 0.4)(1, 512) * 8.0), 'w_mod': _w((lambda *s: torch.randn(*s, dtype=torch.bfloat16) * 0.4)(512, 6 * 512) * 512 ** (-0.5) * 8.0)}

def reference(A_x, A_wqkv, A_w_phi, A_wo, B_x, B_w_gate, B_w_up, B_w_down, c, w_mod):

    def _A_ref(x, wqkv, w_phi, wo):
        B, S, D = x.shape
        H = 32
        Dh = D // H
        qkv = (lambda x, *d: x.permute(*d))((x @ wqkv).reshape(B, S, 3, H, Dh), 2, 0, 3, 1, 4)
        q, k, v = (qkv[0], qkv[1], qkv[2])
        pq = torch.einsum('bhsd,hdf->bhsf', q, w_phi)
        pk = torch.einsum('bhsd,hdf->bhsf', k, w_phi)
        phi_q = torch.concatenate([_softmax(pq, axis=-1), _softmax(-pq, axis=-1)], axis=-1)
        phi_k = torch.concatenate([_softmax(pk, axis=-1), _softmax(-pk, axis=-1)], axis=-1)
        kv = torch.einsum('bhsf,bhsd->bhfd', phi_k, v)
        z = torch.einsum('bhsf->bhf', phi_k)
        num = torch.einsum('bhqf,bhfd->bhqd', phi_q, kv)
        den = torch.einsum('bhqf,bhf->bhq', phi_q, z)[..., None] + 1e-06
        o = num / den
        return (lambda x, *d: x.permute(*d))(o, 0, 2, 1, 3).reshape(B, S, D) @ wo

    def _B_ref(x, w_gate, w_up, w_down):
        g = torch.einsum('bsd,df->bsf', x, w_gate)
        u = torch.einsum('bsd,df->bsf', x, w_up)
        h = _gelu(g) * u
        return torch.einsum('bsf,fd->bsd', h, w_down)
    x = A_x
    mod = (_silu(c) @ w_mod).reshape(c.shape[0], 6, 1, -1)
    sa, ca, ga, sb, cb, gb = (mod[:, 0].clone(), mod[:, 1].clone(), mod[:, 2].clone(), mod[:, 3].clone(), mod[:, 4].clone(), mod[:, 5].clone())
    h = _layernorm(x, axis=-1) * (1 + ca) + sa
    x = x + ga * _A_ref(h, A_wqkv, A_w_phi, A_wo)
    h = _layernorm(x, axis=-1) * (1 + cb) + sb
    x = x + gb * _B_ref(h, B_w_gate, B_w_up, B_w_down)
    return x
```

```asm
; @launch kernel=mega_kernel grid=(256,1,1) block=(1024,1,1) lds=163840
.amdgcn_target "amdgcn-amd-amdhsa--gfx950"
.text
.globl mega_kernel
.p2align 8
.type mega_kernel,@function
mega_kernel:
    s_cmp_ge_u32 s2, 256
    s_cbranch_scc1 MK_END
    s_load_dwordx8 s[4:11], s[0:1], 0
    s_load_dwordx8 s[12:19], s[0:1], 32
    s_load_dwordx8 s[20:27], s[0:1], 64
    s_load_dwordx2 s[28:29], s[0:1], 96
    s_memrealtime s[52:53]
    v_lshrrev_b32 v2, 6, v0
    v_and_b32 v1, 63, v0
    v_readfirstlane_b32 s3, v2
    s_getpc_b64 s[60:61]
MK_PC:
    s_cmp_eq_u32 s3, 0
    s_cbranch_scc0 MK_NI
    s_bfe_u32 s58, s2, 0x20003
    s_lshl_b32 s58, s58, 13
    v_lshlrev_b32 v6, 7, v1
    v_add_u32 v6, s58, v6
    v_min_u32 v6, MK_END-MK_PC, v6
    global_load_dword v30, v6, s[60:61]
MK_NI:
    s_and_b32 s54, s2, 7
    s_lshl_b32 s54, s54, 2
    s_bfe_u32 s55, s2, 0x20003
    s_add_u32 s54, s54, s55
    s_lshr_b32 s55, s2, 5
    s_and_b32 s56, s3, 3
    s_bfe_u32 s57, s3, 0x10002
    v_lshlrev_b32 v8, 2, v1
    v_add_u32 v8, 163584, v8
    s_lshl_b32 s58, s3, 2
    s_add_u32 s58, s58, 163328
    v_writelane_b32 v8, s58, 0
    v_mov_b32 v9, 0
    ds_write_b32 v8, v9
    s_lshl_b32 s59, s2, 4
    s_add_u32 s59, s59, s3
    s_cmp_eq_u32 s59, 0
    s_waitcnt lgkmcnt(0)
    s_cbranch_scc0 MK_A
    s_lshl_b64 s[52:53], s[52:53], 4
    s_mov_b32 s32, s26
    s_mov_b32 s33, s27
    s_mov_b32 s34, 256
    s_mov_b32 s35, 0x00020000
    s_or_b32 s53, s53, 0x80000000
    v_mov_b32 v2, s52
    v_mov_b32 v3, s53
    v_lshlrev_b32 v4, 7, v1
    s_mov_b64 exec, 3
    buffer_store_dwordx2 v[2:3], v4, s[32:35], 0 offen sc1
    s_mov_b64 exec, -1
MK_A:
    s_cmp_lt_u32 s3, 8
    s_cbranch_scc0 MK_B
    s_mov_b32 s32, s20
    s_mov_b32 s33, s21
    s_mov_b32 s34, 0x400
    s_mov_b32 s35, 0x00020000
    s_mov_b32 s36, s22
    s_mov_b32 s37, s23
    s_mov_b32 s38, 0x300000
    s_mov_b32 s39, 0x00020000
    s_cmp_lg_u32 s3, 0
    s_cbranch_scc1 P0_NOW
    s_cmp_ge_u32 s2, 128
    s_cbranch_scc1 P0_NOW
    s_lshr_b32 s58, s2, 3
    s_and_b32 s59, s58, 15
    s_mul_i32 s59, s59, 196608
    s_and_b32 s60, s2, 7
    s_lshl_b32 s60, s60, 7
    s_add_u32 s59, s59, s60
    s_lshr_b32 s58, s58, 4
    s_lshl_b32 s60, s58, 11
    s_add_u32 s59, s59, s60
    v_and_b32 v6, 31, v1
    v_mul_u32_u24 v6, 6144, v6
    v_lshrrev_b32 v7, 5, v1
    v_lshl_add_u32 v6, v7, 10, v6
    buffer_load_dword v28, v6, s[36:39], s59 offen
    s_cmp_eq_u32 s58, 0
    s_cbranch_scc1 P0_NOW
    buffer_load_dword v29, v6, s[36:39], s59 offen offset:2048
P0_NOW:
    s_cmp_lt_u32 s2, 32
    s_cbranch_scc0 MK_B
    v_lshrrev_b32 v7, 2, v1
    v_lshlrev_b32 v6, 3, v7
    s_lshl_b32 s58, s3, 7
    buffer_load_dwordx2 v[16:17], v6, s[32:35], s58 offen
    v_mul_u32_u24 v6, 24576, v7
    v_and_b32 v7, 3, v1
    v_lshl_add_u32 v6, v7, 4, v6
    s_lshr_b32 s59, s2, 4
    s_lshl_b32 s59, s59, 3
    s_and_b32 s60, s2, 7
    s_add_u32 s59, s59, s60
    s_lshl_b32 s59, s59, 1
    s_bfe_u32 s60, s2, 0x10003
    s_add_u32 s59, s59, s60
    s_lshl_b32 s59, s59, 6
    s_mul_i32 s58, s3, 393216
    s_add_u32 s58, s58, s59
    buffer_load_dwordx4 v[32:35], v6, s[36:39], s58 offen
    s_add_u32 s58, s58, 6144
    buffer_load_dwordx4 v[36:39], v6, s[36:39], s58 offen
    s_add_u32 s58, s58, 6144
    buffer_load_dwordx4 v[40:43], v6, s[36:39], s58 offen
    s_add_u32 s58, s58, 6144
    buffer_load_dwordx4 v[44:47], v6, s[36:39], s58 offen
MK_B:
    s_barrier
    s_cmp_ge_u32 s3, 12
    s_cbranch_scc1 MK_PF
    s_cmp_ge_u32 s3, 8
    s_cbranch_scc1 MK_AUX
    v_lshrrev_b32 v2, 3, v1
    v_and_b32 v3, 7, v1
    v_lshlrev_b32 v4, 4, v3
    v_lshl_add_u32 v5, v2, 10, v4
    s_cmp_lt_u32 s2, 32
    s_cselect_b32 s61, 1, 0
    s_mov_b32 s32, s4
    s_mov_b32 s33, s5
    s_mov_b32 s34, 0x200000
    s_mov_b32 s35, 0x00020000
    s_lshl_b32 s58, s54, 16
    s_lshl_b32 s59, s3, 7
    s_add_u32 s58, s58, s59
    buffer_load_dwordx4 v[96:99], v5, s[32:35], s58 offen
    s_add_u32 s58, s58, 8192
    buffer_load_dwordx4 v[100:103], v5, s[32:35], s58 offen
    s_add_u32 s58, s58, 8192
    buffer_load_dwordx4 v[104:107], v5, s[32:35], s58 offen
    s_add_u32 s58, s58, 8192
    buffer_load_dwordx4 v[108:111], v5, s[32:35], s58 offen
    s_add_u32 s58, s58, 8192
    buffer_load_dwordx4 v[112:115], v5, s[32:35], s58 offen
    s_add_u32 s58, s58, 8192
    buffer_load_dwordx4 v[116:119], v5, s[32:35], s58 offen
    s_add_u32 s58, s58, 8192
    buffer_load_dwordx4 v[120:123], v5, s[32:35], s58 offen
    s_add_u32 s58, s58, 8192
    buffer_load_dwordx4 v[124:127], v5, s[32:35], s58 offen
    v_mov_b32 v9, 2
    ds_write_b32 v8, v9
    s_sub_u32 s59, s2, 192
    s_cmp_eq_u32 s3, 0
    s_cselect_b32 s58, s59, 255
    s_cmp_lt_u32 s58, 34
    s_cbranch_scc0 P0_NOZ
    s_add_u32 s36, s28, 0xe80000
    s_addc_u32 s37, s29, 0
    s_mov_b32 s38, 0x24200
    s_mov_b32 s39, 0x00020000
    v_mov_b32 v16, 0
    v_mov_b32 v17, 0
    v_mov_b32 v18, 0
    v_mov_b32 v19, 0
    v_lshlrev_b32 v6, 4, v1
    v_min_u32 v7, 240, v6
    s_mul_i32 s58, s58, 4352
    buffer_store_dwordx4 v[16:19], v6, s[36:39], s58 offen offset:0 sc1
    buffer_store_dwordx4 v[16:19], v6, s[36:39], s58 offen offset:1024 sc1
    buffer_store_dwordx4 v[16:19], v6, s[36:39], s58 offen offset:2048 sc1
    buffer_store_dwordx4 v[16:19], v6, s[36:39], s58 offen offset:3072 sc1
    s_add_u32 s58, s58, 4096
    buffer_store_dwordx4 v[16:19], v7, s[36:39], s58 offen sc1
P0_NOZ:
    s_cmp_eq_u32 s61, 1
    s_cbranch_scc0 P0_NOG2
    s_waitcnt vmcnt(12)
    v_lshlrev_b32 v20, 16, v16
    v_and_b32 v21, 0xffff0000, v16
    v_lshlrev_b32 v22, 16, v17
    v_and_b32 v23, 0xffff0000, v17
    s_mov_b32 s58, 0xbfb8aa3b
    v_mul_f32 v64, s58, v20
    v_mul_f32 v65, s58, v21
    v_mul_f32 v66, s58, v22
    v_mul_f32 v67, s58, v23
    v_exp_f32 v64, v64
    v_exp_f32 v65, v65
    v_exp_f32 v66, v66
    v_exp_f32 v67, v67
    v_add_f32 v64, 1.0, v64
    v_add_f32 v65, 1.0, v65
    v_add_f32 v66, 1.0, v66
    v_add_f32 v67, 1.0, v67
    v_rcp_f32 v64, v64
    v_rcp_f32 v65, v65
    v_rcp_f32 v66, v66
    v_rcp_f32 v67, v67
    v_mul_f32 v20, v20, v64
    v_mul_f32 v21, v21, v65
    v_mul_f32 v22, v22, v66
    v_mul_f32 v23, v23, v67
    v_cvt_pk_bf16_f32 v64, v20, v21
    v_cvt_pk_bf16_f32 v65, v22, v23
    v_lshlrev_b32 v20, 16, v64
    v_and_b32 v21, 0xffff0000, v64
    v_lshlrev_b32 v22, 16, v65
    v_and_b32 v23, 0xffff0000, v65
    v_lshrrev_b32 v6, 4, v1
    v_and_b32 v7, 3, v1
    v_lshlrev_b32 v6, 3, v6
    v_lshl_add_u32 v6, v7, 5, v6
    s_lshl_b32 s58, s3, 7
    s_add_u32 s58, s58, 0
    v_add_u32 v6, s58, v6
    s_waitcnt vmcnt(11)
    v_lshlrev_b32 v64, 16, v32
    v_and_b32 v65, 0xffff0000, v32
    v_lshlrev_b32 v66, 16, v33
    v_and_b32 v67, 0xffff0000, v33
    v_lshlrev_b32 v68, 16, v34
    v_and_b32 v69, 0xffff0000, v34
    v_lshlrev_b32 v70, 16, v35
    v_and_b32 v71, 0xffff0000, v35
    v_pk_mul_f32 v[72:73], v[64:65], v[20:21] op_sel_hi:[1,0]
    v_pk_mul_f32 v[74:75], v[66:67], v[20:21] op_sel_hi:[1,0]
    v_pk_mul_f32 v[76:77], v[68:69], v[20:21] op_sel_hi:[1,0]
    v_pk_mul_f32 v[78:79], v[70:71], v[20:21] op_sel_hi:[1,0]
    s_waitcnt vmcnt(10)
    v_lshlrev_b32 v64, 16, v36
    v_and_b32 v65, 0xffff0000, v36
    v_lshlrev_b32 v66, 16, v37
    v_and_b32 v67, 0xffff0000, v37
    v_lshlrev_b32 v68, 16, v38
    v_and_b32 v69, 0xffff0000, v38
    v_lshlrev_b32 v70, 16, v39
    v_and_b32 v71, 0xffff0000, v39
    v_pk_fma_f32 v[72:73], v[64:65], v[20:21], v[72:73] op_sel:[0,1,0] op_sel_hi:[1,1,1]
    v_pk_fma_f32 v[74:75], v[66:67], v[20:21], v[74:75] op_sel:[0,1,0] op_sel_hi:[1,1,1]
    v_pk_fma_f32 v[76:77], v[68:69], v[20:21], v[76:77] op_sel:[0,1,0] op_sel_hi:[1,1,1]
    v_pk_fma_f32 v[78:79], v[70:71], v[20:21], v[78:79] op_sel:[0,1,0] op_sel_hi:[1,1,1]
    s_waitcnt vmcnt(9)
    v_lshlrev_b32 v64, 16, v40
    v_and_b32 v65, 0xffff0000, v40
    v_lshlrev_b32 v66, 16, v41
    v_and_b32 v67, 0xffff0000, v41
    v_lshlrev_b32 v68, 16, v42
    v_and_b32 v69, 0xffff0000, v42
    v_lshlrev_b32 v70, 16, v43
    v_and_b32 v71, 0xffff0000, v43
    v_pk_fma_f32 v[72:73], v[64:65], v[22:23], v[72:73] op_sel_hi:[1,0,1]
    v_pk_fma_f32 v[74:75], v[66:67], v[22:23], v[74:75] op_sel_hi:[1,0,1]
    v_pk_fma_f32 v[76:77], v[68:69], v[22:23], v[76:77] op_sel_hi:[1,0,1]
    v_pk_fma_f32 v[78:79], v[70:71], v[22:23], v[78:79] op_sel_hi:[1,0,1]
    s_waitcnt vmcnt(8)
    v_lshlrev_b32 v64, 16, v44
    v_and_b32 v65, 0xffff0000, v44
    v_lshlrev_b32 v66, 16, v45
    v_and_b32 v67, 0xffff0000, v45
    v_lshlrev_b32 v68, 16, v46
    v_and_b32 v69, 0xffff0000, v46
    v_lshlrev_b32 v70, 16, v47
    v_and_b32 v71, 0xffff0000, v47
    v_pk_fma_f32 v[72:73], v[64:65], v[22:23], v[72:73] op_sel:[0,1,0] op_sel_hi:[1,1,1]
    v_pk_fma_f32 v[74:75], v[66:67], v[22:23], v[74:75] op_sel:[0,1,0] op_sel_hi:[1,1,1]
    v_pk_fma_f32 v[76:77], v[68:69], v[22:23], v[76:77] op_sel:[0,1,0] op_sel_hi:[1,1,1]
    v_pk_fma_f32 v[78:79], v[70:71], v[22:23], v[78:79] op_sel:[0,1,0] op_sel_hi:[1,1,1]
    s_nop 0
    v_permlane32_swap_b32 v72, v76
    v_permlane32_swap_b32 v73, v77
    v_permlane32_swap_b32 v74, v78
    v_permlane32_swap_b32 v75, v79
    v_pk_add_f32 v[72:73], v[72:73], v[76:77]
    v_pk_add_f32 v[74:75], v[74:75], v[78:79]
    s_nop 1
    v_permlane16_swap_b32 v72, v74
    v_permlane16_swap_b32 v73, v75
    v_pk_add_f32 v[72:73], v[72:73], v[74:75]
    s_nop 1
    v_add_f32_dpp v74, v72, v72 row_ror:8 row_mask:0xf bank_mask:0xf
    v_add_f32_dpp v75, v73, v73 row_ror:8 row_mask:0xf bank_mask:0xf
    v_mov_b32 v72, v74
    v_mov_b32 v73, v75
    s_nop 0
    v_add_f32_dpp v74, v72, v72 row_ror:4 row_mask:0xf bank_mask:0xf
    v_add_f32_dpp v75, v73, v73 row_ror:4 row_mask:0xf bank_mask:0xf
    ds_write_b64 v6, v[74:75]
    v_mov_b32 v9, 3
    ds_write_b32 v8, v9
P0_NOG2:
    s_waitcnt vmcnt(0)
    v_mov_b32 v9, 4
    ds_write_b32 v8, v9
    v_mov_b32 v6, 0x3f803f80
    v_dot2_f32_bf16 v16, v96, v6, 0
    v_dot2_f32_bf16 v17, v96, v96, 0
    v_dot2_f32_bf16 v18, v100, v6, 0
    v_dot2_f32_bf16 v19, v100, v100, 0
    v_dot2_f32_bf16 v20, v104, v6, 0
    v_dot2_f32_bf16 v21, v104, v104, 0
    v_dot2_f32_bf16 v22, v108, v6, 0
    v_dot2_f32_bf16 v23, v108, v108, 0
    v_dot2_f32_bf16 v24, v112, v6, 0
    v_dot2_f32_bf16 v25, v112, v112, 0
    v_dot2_f32_bf16 v26, v116, v6, 0
    v_dot2_f32_bf16 v27, v116, v116, 0
    v_dot2_f32_bf16 v28, v120, v6, 0
    v_dot2_f32_bf16 v29, v120, v120, 0
    v_dot2_f32_bf16 v30, v124, v6, 0
    v_dot2_f32_bf16 v31, v124, v124, 0
    v_dot2_f32_bf16 v16, v97, v6, v16
    v_dot2_f32_bf16 v17, v97, v97, v17
    v_dot2_f32_bf16 v18, v101, v6, v18
    v_dot2_f32_bf16 v19, v101, v101, v19
    v_dot2_f32_bf16 v20, v105, v6, v20
    v_dot2_f32_bf16 v21, v105, v105, v21
    v_dot2_f32_bf16 v22, v109, v6, v22
    v_dot2_f32_bf16 v23, v109, v109, v23
    v_dot2_f32_bf16 v24, v113, v6, v24
    v_dot2_f32_bf16 v25, v113, v113, v25
    v_dot2_f32_bf16 v26, v117, v6, v26
    v_dot2_f32_bf16 v27, v117, v117, v27
    v_dot2_f32_bf16 v28, v121, v6, v28
    v_dot2_f32_bf16 v29, v121, v121, v29
    v_dot2_f32_bf16 v30, v125, v6, v30
    v_dot2_f32_bf16 v31, v125, v125, v31
    v_dot2_f32_bf16 v16, v98, v6, v16
    v_dot2_f32_bf16 v17, v98, v98, v17
    v_dot2_f32_bf16 v18, v102, v6, v18
    v_dot2_f32_bf16 v19, v102, v102, v19
    v_dot2_f32_bf16 v20, v106, v6, v20
    v_dot2_f32_bf16 v21, v106, v106, v21
    v_dot2_f32_bf16 v22, v110, v6, v22
    v_dot2_f32_bf16 v23, v110, v110, v23
    v_dot2_f32_bf16 v24, v114, v6, v24
    v_dot2_f32_bf16 v25, v114, v114, v25
    v_dot2_f32_bf16 v26, v118, v6, v26
    v_dot2_f32_bf16 v27, v118, v118, v27
    v_dot2_f32_bf16 v28, v122, v6, v28
    v_dot2_f32_bf16 v29, v122, v122, v29
    v_dot2_f32_bf16 v30, v126, v6, v30
    v_dot2_f32_bf16 v31, v126, v126, v31
    v_dot2_f32_bf16 v16, v99, v6, v16
    v_dot2_f32_bf16 v17, v99, v99, v17
    v_dot2_f32_bf16 v18, v103, v6, v18
    v_dot2_f32_bf16 v19, v103, v103, v19
    v_dot2_f32_bf16 v20, v107, v6, v20
    v_dot2_f32_bf16 v21, v107, v107, v21
    v_dot2_f32_bf16 v22, v111, v6, v22
    v_dot2_f32_bf16 v23, v111, v111, v23
    v_dot2_f32_bf16 v24, v115, v6, v24
    v_dot2_f32_bf16 v25, v115, v115, v25
    v_dot2_f32_bf16 v26, v119, v6, v26
    v_dot2_f32_bf16 v27, v119, v119, v27
    v_dot2_f32_bf16 v28, v123, v6, v28
    v_dot2_f32_bf16 v29, v123, v123, v29
    v_dot2_f32_bf16 v30, v127, v6, v30
    v_dot2_f32_bf16 v31, v127, v127, v31
    v_add_f32_dpp v16, v16, v16 quad_perm:[1,0,3,2] row_mask:0xf bank_mask:0xf
    v_add_f32_dpp v17, v17, v17 quad_perm:[1,0,3,2] row_mask:0xf bank_mask:0xf
    v_add_f32_dpp v18, v18, v18 quad_perm:[1,0,3,2] row_mask:0xf bank_mask:0xf
    v_add_f32_dpp v19, v19, v19 quad_perm:[1,0,3,2] row_mask:0xf bank_mask:0xf
    v_add_f32_dpp v20, v20, v20 quad_perm:[1,0,3,2] row_mask:0xf bank_mask:0xf
    v_add_f32_dpp v21, v21, v21 quad_perm:[1,0,3,2] row_mask:0xf bank_mask:0xf
    v_add_f32_dpp v22, v22, v22 quad_perm:[1,0,3,2] row_mask:0xf bank_mask:0xf
    v_add_f32_dpp v23, v23, v23 quad_perm:[1,0,3,2] row_mask:0xf bank_mask:0xf
    v_add_f32_dpp v24, v24, v24 quad_perm:[1,0,3,2] row_mask:0xf bank_mask:0xf
    v_add_f32_dpp v25, v25, v25 quad_perm:[1,0,3,2] row_mask:0xf bank_mask:0xf
    v_add_f32_dpp v26, v26, v26 quad_perm:[1,0,3,2] row_mask:0xf bank_mask:0xf
    v_add_f32_dpp v27, v27, v27 quad_perm:[1,0,3,2] row_mask:0xf bank_mask:0xf
    v_add_f32_dpp v28, v28, v28 quad_perm:[1,0,3,2] row_mask:0xf bank_mask:0xf
    v_add_f32_dpp v29, v29, v29 quad_perm:[1,0,3,2] row_mask:0xf bank_mask:0xf
    v_add_f32_dpp v30, v30, v30 quad_perm:[1,0,3,2] row_mask:0xf bank_mask:0xf
    v_add_f32_dpp v31, v31, v31 quad_perm:[1,0,3,2] row_mask:0xf bank_mask:0xf
    v_add_f32_dpp v16, v16, v16 quad_perm:[2,3,0,1] row_mask:0xf bank_mask:0xf
    v_add_f32_dpp v17, v17, v17 quad_perm:[2,3,0,1] row_mask:0xf bank_mask:0xf
    v_add_f32_dpp v18, v18, v18 quad_perm:[2,3,0,1] row_mask:0xf bank_mask:0xf
    v_add_f32_dpp v19, v19, v19 quad_perm:[2,3,0,1] row_mask:0xf bank_mask:0xf
    v_add_f32_dpp v20, v20, v20 quad_perm:[2,3,0,1] row_mask:0xf bank_mask:0xf
    v_add_f32_dpp v21, v21, v21 quad_perm:[2,3,0,1] row_mask:0xf bank_mask:0xf
    v_add_f32_dpp v22, v22, v22 quad_perm:[2,3,0,1] row_mask:0xf bank_mask:0xf
    v_add_f32_dpp v23, v23, v23 quad_perm:[2,3,0,1] row_mask:0xf bank_mask:0xf
    v_add_f32_dpp v24, v24, v24 quad_perm:[2,3,0,1] row_mask:0xf bank_mask:0xf
    v_add_f32_dpp v25, v25, v25 quad_perm:[2,3,0,1] row_mask:0xf bank_mask:0xf
    v_add_f32_dpp v26, v26, v26 quad_perm:[2,3,0,1] row_mask:0xf bank_mask:0xf
    v_add_f32_dpp v27, v27, v27 quad_perm:[2,3,0,1] row_mask:0xf bank_mask:0xf
    v_add_f32_dpp v28, v28, v28 quad_perm:[2,3,0,1] row_mask:0xf bank_mask:0xf
    v_add_f32_dpp v29, v29, v29 quad_perm:[2,3,0,1] row_mask:0xf bank_mask:0xf
    v_add_f32_dpp v30, v30, v30 quad_perm:[2,3,0,1] row_mask:0xf bank_mask:0xf
    v_add_f32_dpp v31, v31, v31 quad_perm:[2,3,0,1] row_mask:0xf bank_mask:0xf
    v_add_f32_dpp v16, v16, v16 row_half_mirror row_mask:0xf bank_mask:0xf
    v_add_f32_dpp v17, v17, v17 row_half_mirror row_mask:0xf bank_mask:0xf
    v_add_f32_dpp v18, v18, v18 row_half_mirror row_mask:0xf bank_mask:0xf
    v_add_f32_dpp v19, v19, v19 row_half_mirror row_mask:0xf bank_mask:0xf
    v_add_f32_dpp v20, v20, v20 row_half_mirror row_mask:0xf bank_mask:0xf
    v_add_f32_dpp v21, v21, v21 row_half_mirror row_mask:0xf bank_mask:0xf
    v_add_f32_dpp v22, v22, v22 row_half_mirror row_mask:0xf bank_mask:0xf
    v_add_f32_dpp v23, v23, v23 row_half_mirror row_mask:0xf bank_mask:0xf
    v_add_f32_dpp v24, v24, v24 row_half_mirror row_mask:0xf bank_mask:0xf
    v_add_f32_dpp v25, v25, v25 row_half_mirror row_mask:0xf bank_mask:0xf
    v_add_f32_dpp v26, v26, v26 row_half_mirror row_mask:0xf bank_mask:0xf
    v_add_f32_dpp v27, v27, v27 row_half_mirror row_mask:0xf bank_mask:0xf
    v_add_f32_dpp v28, v28, v28 row_half_mirror row_mask:0xf bank_mask:0xf
    v_add_f32_dpp v29, v29, v29 row_half_mirror row_mask:0xf bank_mask:0xf
    v_add_f32_dpp v30, v30, v30 row_half_mirror row_mask:0xf bank_mask:0xf
    v_add_f32_dpp v31, v31, v31 row_half_mirror row_mask:0xf bank_mask:0xf
    v_lshlrev_b32 v6, 6, v2
    s_lshl_b32 s58, s3, 3
    s_add_u32 s58, s58, 156672
    v_add_u32 v6, s58, v6
    s_mov_b32 s58, 0x01010101
    s_mov_b32 exec_lo, s58
    s_mov_b32 exec_hi, s58
    ds_write_b64 v6, v[16:17] offset:0
    ds_write_b64 v6, v[18:19] offset:512
    ds_write_b64 v6, v[20:21] offset:1024
    ds_write_b64 v6, v[22:23] offset:1536
    ds_write_b64 v6, v[24:25] offset:2048
    ds_write_b64 v6, v[26:27] offset:2560
    ds_write_b64 v6, v[28:29] offset:3072
    ds_write_b64 v6, v[30:31] offset:3584
    s_mov_b64 exec, -1
    v_mov_b32 v9, 5
    ds_write_b32 v8, v9
    v_lshlrev_b32 v32, 16, v96
    v_and_b32 v33, 0xffff0000, v96
    v_lshlrev_b32 v34, 16, v97
    v_and_b32 v35, 0xffff0000, v97
    v_lshlrev_b32 v36, 16, v98
    v_and_b32 v37, 0xffff0000, v98
    v_lshlrev_b32 v38, 16, v99
    v_and_b32 v39, 0xffff0000, v99
    v_lshlrev_b32 v40, 16, v100
    v_and_b32 v41, 0xffff0000, v100
    v_lshlrev_b32 v42, 16, v101
    v_and_b32 v43, 0xffff0000, v101
    v_lshlrev_b32 v44, 16, v102
    v_and_b32 v45, 0xffff0000, v102
    v_lshlrev_b32 v46, 16, v103
    v_and_b32 v47, 0xffff0000, v103
    v_lshlrev_b32 v48, 16, v104
    v_and_b32 v49, 0xffff0000, v104
    v_lshlrev_b32 v50, 16, v105
    v_and_b32 v51, 0xffff0000, v105
    v_lshlrev_b32 v52, 16, v106
    v_and_b32 v53, 0xffff0000, v106
    v_lshlrev_b32 v54, 16, v107
    v_and_b32 v55, 0xffff0000, v107
    v_lshlrev_b32 v56, 16, v108
    v_and_b32 v57, 0xffff0000, v108
    v_lshlrev_b32 v58, 16, v109
    v_and_b32 v59, 0xffff0000, v109
    v_lshlrev_b32 v60, 16, v110
    v_and_b32 v61, 0xffff0000, v110
    v_lshlrev_b32 v62, 16, v111
    v_and_b32 v63, 0xffff0000, v111
    v_lshlrev_b32 v64, 16, v112
    v_and_b32 v65, 0xffff0000, v112
    v_lshlrev_b32 v66, 16, v113
    v_and_b32 v67, 0xffff0000, v113
    v_lshlrev_b32 v68, 16, v114
    v_and_b32 v69, 0xffff0000, v114
    v_lshlrev_b32 v70, 16, v115
    v_and_b32 v71, 0xffff0000, v115
    v_lshlrev_b32 v72, 16, v116
    v_and_b32 v73, 0xffff0000, v116
    v_lshlrev_b32 v74, 16, v117
    v_and_b32 v75, 0xffff0000, v117
    v_lshlrev_b32 v76, 16, v118
    v_and_b32 v77, 0xffff0000, v118
    v_lshlrev_b32 v78, 16, v119
    v_and_b32 v79, 0xffff0000, v119
    v_lshlrev_b32 v80, 16, v120
    v_and_b32 v81, 0xffff0000, v120
    v_lshlrev_b32 v82, 16, v121
    v_and_b32 v83, 0xffff0000, v121
    v_lshlrev_b32 v84, 16, v122
    v_and_b32 v85, 0xffff0000, v122
    v_lshlrev_b32 v86, 16, v123
    v_and_b32 v87, 0xffff0000, v123
    v_lshlrev_b32 v88, 16, v124
    v_and_b32 v89, 0xffff0000, v124
    v_lshlrev_b32 v90, 16, v125
    v_and_b32 v91, 0xffff0000, v125
    v_lshlrev_b32 v92, 16, v126
    v_and_b32 v93, 0xffff0000, v126
    v_lshlrev_b32 v94, 16, v127
    v_and_b32 v95, 0xffff0000, v127
    v_and_b32 v10, 7, v1
    v_lshlrev_b32 v10, 2, v10
    v_add_u32 v10, 163328, v10
    s_mov_b32 s59, 0x4000
LW_1:
    ds_read_b32 v9, v10
    s_waitcnt lgkmcnt(0)
    v_cmp_gt_u32 vcc, 5, v9
    s_cbranch_vccz LW_1_D
    s_sub_u32 s59, s59, 1
    s_cmp_lg_u32 s59, 0
    s_cbranch_scc1 LW_1
LW_1_D:
    v_lshlrev_b32 v6, 6, v1
    v_add_u32 v6, 156672, v6
    ds_read_b128 v[96:99], v6 offset:0
    ds_read_b128 v[100:103], v6 offset:16
    ds_read_b128 v[104:107], v6 offset:32
    ds_read_b128 v[108:111], v6 offset:48
    s_waitcnt lgkmcnt(0)
    v_pk_add_f32 v[96:97], v[96:97], v[98:99]
    v_pk_add_f32 v[100:101], v[100:101], v[102:103]
    v_pk_add_f32 v[104:105], v[104:105], v[106:107]
    v_pk_add_f32 v[108:109], v[108:109], v[110:111]
    v_pk_add_f32 v[96:97], v[96:97], v[100:101]
    v_pk_add_f32 v[104:105], v[104:105], v[108:109]
    v_pk_add_f32 v[96:97], v[96:97], v[104:105]
    v_mul_f32 v96, 0x3b000000, v96
    v_mul_f32 v97, 0x3b000000, v97
    v_fma_f32 v97, -v96, v96, v97
    v_max_f32 v97, 0, v97
    v_add_f32 v97, 0x3727c5ac, v97
    v_rsq_f32 v97, v97
    v_lshlrev_b32 v6, 2, v2
    v_mul_f32 v96, v96, v97
    v_sub_f32 v96, 0, v96
    ds_bpermute_b32 v100, v6, v97 offset:0
    ds_bpermute_b32 v101, v6, v96 offset:0
    ds_bpermute_b32 v102, v6, v97 offset:32
    ds_bpermute_b32 v103, v6, v96 offset:32
    ds_bpermute_b32 v104, v6, v97 offset:64
    ds_bpermute_b32 v105, v6, v96 offset:64
    ds_bpermute_b32 v106, v6, v97 offset:96
    ds_bpermute_b32 v107, v6, v96 offset:96
    ds_bpermute_b32 v108, v6, v97 offset:128
    ds_bpermute_b32 v109, v6, v96 offset:128
    ds_bpermute_b32 v110, v6, v97 offset:160
    ds_bpermute_b32 v111, v6, v96 offset:160
    ds_bpermute_b32 v112, v6, v97 offset:192
    ds_bpermute_b32 v113, v6, v96 offset:192
    ds_bpermute_b32 v114, v6, v97 offset:224
    ds_bpermute_b32 v115, v6, v96 offset:224
    s_waitcnt lgkmcnt(14)
    v_pk_fma_f32 v[32:33], v[32:33], v[100:101], v[100:101] op_sel:[0,0,1] op_sel_hi:[1,0,1]
    v_pk_fma_f32 v[34:35], v[34:35], v[100:101], v[100:101] op_sel:[0,0,1] op_sel_hi:[1,0,1]
    v_pk_fma_f32 v[36:37], v[36:37], v[100:101], v[100:101] op_sel:[0,0,1] op_sel_hi:[1,0,1]
    v_pk_fma_f32 v[38:39], v[38:39], v[100:101], v[100:101] op_sel:[0,0,1] op_sel_hi:[1,0,1]
    s_waitcnt lgkmcnt(12)
    v_pk_fma_f32 v[40:41], v[40:41], v[102:103], v[102:103] op_sel:[0,0,1] op_sel_hi:[1,0,1]
    v_pk_fma_f32 v[42:43], v[42:43], v[102:103], v[102:103] op_sel:[0,0,1] op_sel_hi:[1,0,1]
    v_pk_fma_f32 v[44:45], v[44:45], v[102:103], v[102:103] op_sel:[0,0,1] op_sel_hi:[1,0,1]
    v_pk_fma_f32 v[46:47], v[46:47], v[102:103], v[102:103] op_sel:[0,0,1] op_sel_hi:[1,0,1]
    s_waitcnt lgkmcnt(10)
    v_pk_fma_f32 v[48:49], v[48:49], v[104:105], v[104:105] op_sel:[0,0,1] op_sel_hi:[1,0,1]
    v_pk_fma_f32 v[50:51], v[50:51], v[104:105], v[104:105] op_sel:[0,0,1] op_sel_hi:[1,0,1]
    v_pk_fma_f32 v[52:53], v[52:53], v[104:105], v[104:105] op_sel:[0,0,1] op_sel_hi:[1,0,1]
    v_pk_fma_f32 v[54:55], v[54:55], v[104:105], v[104:105] op_sel:[0,0,1] op_sel_hi:[1,0,1]
    s_waitcnt lgkmcnt(8)
    v_pk_fma_f32 v[56:57], v[56:57], v[106:107], v[106:107] op_sel:[0,0,1] op_sel_hi:[1,0,1]
    v_pk_fma_f32 v[58:59], v[58:59], v[106:107], v[106:107] op_sel:[0,0,1] op_sel_hi:[1,0,1]
    v_pk_fma_f32 v[60:61], v[60:61], v[106:107], v[106:107] op_sel:[0,0,1] op_sel_hi:[1,0,1]
    v_pk_fma_f32 v[62:63], v[62:63], v[106:107], v[106:107] op_sel:[0,0,1] op_sel_hi:[1,0,1]
    s_waitcnt lgkmcnt(6)
    v_pk_fma_f32 v[64:65], v[64:65], v[108:109], v[108:109] op_sel:[0,0,1] op_sel_hi:[1,0,1]
    v_pk_fma_f32 v[66:67], v[66:67], v[108:109], v[108:109] op_sel:[0,0,1] op_sel_hi:[1,0,1]
    v_pk_fma_f32 v[68:69], v[68:69], v[108:109], v[108:109] op_sel:[0,0,1] op_sel_hi:[1,0,1]
    v_pk_fma_f32 v[70:71], v[70:71], v[108:109], v[108:109] op_sel:[0,0,1] op_sel_hi:[1,0,1]
    s_waitcnt lgkmcnt(4)
    v_pk_fma_f32 v[72:73], v[72:73], v[110:111], v[110:111] op_sel:[0,0,1] op_sel_hi:[1,0,1]
    v_pk_fma_f32 v[74:75], v[74:75], v[110:111], v[110:111] op_sel:[0,0,1] op_sel_hi:[1,0,1]
    v_pk_fma_f32 v[76:77], v[76:77], v[110:111], v[110:111] op_sel:[0,0,1] op_sel_hi:[1,0,1]
    v_pk_fma_f32 v[78:79], v[78:79], v[110:111], v[110:111] op_sel:[0,0,1] op_sel_hi:[1,0,1]
    s_waitcnt lgkmcnt(2)
    v_pk_fma_f32 v[80:81], v[80:81], v[112:113], v[112:113] op_sel:[0,0,1] op_sel_hi:[1,0,1]
    v_pk_fma_f32 v[82:83], v[82:83], v[112:113], v[112:113] op_sel:[0,0,1] op_sel_hi:[1,0,1]
    v_pk_fma_f32 v[84:85], v[84:85], v[112:113], v[112:113] op_sel:[0,0,1] op_sel_hi:[1,0,1]
    v_pk_fma_f32 v[86:87], v[86:87], v[112:113], v[112:113] op_sel:[0,0,1] op_sel_hi:[1,0,1]
    s_waitcnt lgkmcnt(0)
    v_pk_fma_f32 v[88:89], v[88:89], v[114:115], v[114:115] op_sel:[0,0,1] op_sel_hi:[1,0,1]
    v_pk_fma_f32 v[90:91], v[90:91], v[114:115], v[114:115] op_sel:[0,0,1] op_sel_hi:[1,0,1]
    v_pk_fma_f32 v[92:93], v[92:93], v[114:115], v[114:115] op_sel:[0,0,1] op_sel_hi:[1,0,1]
    v_pk_fma_f32 v[94:95], v[94:95], v[114:115], v[114:115] op_sel:[0,0,1] op_sel_hi:[1,0,1]
    v_mul_u32_u24 v6, 1040, v3
    v_lshl_add_u32 v6, v2, 4, v6
    s_mul_i32 s58, s3, 8320
    v_add_u32 v6, s58, v6
    s_lshl_b32 s58, s3, 7
    s_add_u32 s58, s58, 148480
    v_add_u32 v7, s58, v4
    v_mov_b32 v10, 163376
    s_mov_b32 s59, 0x4000
LW_2:
    ds_read_b32 v9, v10
    s_waitcnt lgkmcnt(0)
    v_cmp_gt_u32 vcc, 2, v9
    s_cbranch_vccz LW_2_D
    s_sub_u32 s59, s59, 1
    s_cmp_lg_u32 s59, 0
    s_cbranch_scc1 LW_2
LW_2_D:
    ds_read_b128 v[104:107], v7 offset:1024
    ds_read_b128 v[108:111], v7
    s_waitcnt lgkmcnt(1)
    v_lshlrev_b32 v112, 16, v104
    v_and_b32 v113, 0xffff0000, v104
    v_lshlrev_b32 v114, 16, v105
    v_and_b32 v115, 0xffff0000, v105
    v_lshlrev_b32 v116, 16, v106
    v_and_b32 v117, 0xffff0000, v106
    v_lshlrev_b32 v118, 16, v107
    v_and_b32 v119, 0xffff0000, v107
    s_waitcnt lgkmcnt(0)
    v_lshlrev_b32 v120, 16, v108
    v_and_b32 v121, 0xffff0000, v108
    v_lshlrev_b32 v122, 16, v109
    v_and_b32 v123, 0xffff0000, v109
    v_lshlrev_b32 v124, 16, v110
    v_and_b32 v125, 0xffff0000, v110
    v_lshlrev_b32 v126, 16, v111
    v_and_b32 v127, 0xffff0000, v111
    v_pk_fma_f32 v[32:33], v[32:33], v[112:113], v[120:121]
    v_pk_fma_f32 v[34:35], v[34:35], v[114:115], v[122:123]
    v_pk_fma_f32 v[36:37], v[36:37], v[116:117], v[124:125]
    v_pk_fma_f32 v[38:39], v[38:39], v[118:119], v[126:127]
    v_cvt_pk_bf16_f32 v96, v32, v33
    v_cvt_pk_bf16_f32 v97, v34, v35
    v_cvt_pk_bf16_f32 v98, v36, v37
    v_cvt_pk_bf16_f32 v99, v38, v39
    ds_write_b128 v6, v[96:99] offset:0
    v_pk_fma_f32 v[40:41], v[40:41], v[112:113], v[120:121]
    v_pk_fma_f32 v[42:43], v[42:43], v[114:115], v[122:123]
    v_pk_fma_f32 v[44:45], v[44:45], v[116:117], v[124:125]
    v_pk_fma_f32 v[46:47], v[46:47], v[118:119], v[126:127]
    v_cvt_pk_bf16_f32 v100, v40, v41
    v_cvt_pk_bf16_f32 v101, v42, v43
    v_cvt_pk_bf16_f32 v102, v44, v45
    v_cvt_pk_bf16_f32 v103, v46, v47
    ds_write_b128 v6, v[100:103] offset:128
    v_pk_fma_f32 v[48:49], v[48:49], v[112:113], v[120:121]
    v_pk_fma_f32 v[50:51], v[50:51], v[114:115], v[122:123]
    v_pk_fma_f32 v[52:53], v[52:53], v[116:117], v[124:125]
    v_pk_fma_f32 v[54:55], v[54:55], v[118:119], v[126:127]
    v_cvt_pk_bf16_f32 v104, v48, v49
    v_cvt_pk_bf16_f32 v105, v50, v51
    v_cvt_pk_bf16_f32 v106, v52, v53
    v_cvt_pk_bf16_f32 v107, v54, v55
    ds_write_b128 v6, v[104:107] offset:256
    v_pk_fma_f32 v[56:57], v[56:57], v[112:113], v[120:121]
    v_pk_fma_f32 v[58:59], v[58:59], v[114:115], v[122:123]
    v_pk_fma_f32 v[60:61], v[60:61], v[116:117], v[124:125]
    v_pk_fma_f32 v[62:63], v[62:63], v[118:119], v[126:127]
    v_cvt_pk_bf16_f32 v108, v56, v57
    v_cvt_pk_bf16_f32 v109, v58, v59
    v_cvt_pk_bf16_f32 v110, v60, v61
    v_cvt_pk_bf16_f32 v111, v62, v63
    ds_write_b128 v6, v[108:111] offset:384
    v_pk_fma_f32 v[64:65], v[64:65], v[112:113], v[120:121]
    v_pk_fma_f32 v[66:67], v[66:67], v[114:115], v[122:123]
    v_pk_fma_f32 v[68:69], v[68:69], v[116:117], v[124:125]
    v_pk_fma_f32 v[70:71], v[70:71], v[118:119], v[126:127]
    v_cvt_pk_bf16_f32 v96, v64, v65
    v_cvt_pk_bf16_f32 v97, v66, v67
    v_cvt_pk_bf16_f32 v98, v68, v69
    v_cvt_pk_bf16_f32 v99, v70, v71
    ds_write_b128 v6, v[96:99] offset:512
    v_pk_fma_f32 v[72:73], v[72:73], v[112:113], v[120:121]
    v_pk_fma_f32 v[74:75], v[74:75], v[114:115], v[122:123]
    v_pk_fma_f32 v[76:77], v[76:77], v[116:117], v[124:125]
    v_pk_fma_f32 v[78:79], v[78:79], v[118:119], v[126:127]
    v_cvt_pk_bf16_f32 v100, v72, v73
    v_cvt_pk_bf16_f32 v101, v74, v75
    v_cvt_pk_bf16_f32 v102, v76, v77
    v_cvt_pk_bf16_f32 v103, v78, v79
    ds_write_b128 v6, v[100:103] offset:640
    v_pk_fma_f32 v[80:81], v[80:81], v[112:113], v[120:121]
    v_pk_fma_f32 v[82:83], v[82:83], v[114:115], v[122:123]
    v_pk_fma_f32 v[84:85], v[84:85], v[116:117], v[124:125]
    v_pk_fma_f32 v[86:87], v[86:87], v[118:119], v[126:127]
    v_cvt_pk_bf16_f32 v104, v80, v81
    v_cvt_pk_bf16_f32 v105, v82, v83
    v_cvt_pk_bf16_f32 v106, v84, v85
    v_cvt_pk_bf16_f32 v107, v86, v87
    ds_write_b128 v6, v[104:107] offset:768
    v_pk_fma_f32 v[88:89], v[88:89], v[112:113], v[120:121]
    v_pk_fma_f32 v[90:91], v[90:91], v[114:115], v[122:123]
    v_pk_fma_f32 v[92:93], v[92:93], v[116:117], v[124:125]
    v_pk_fma_f32 v[94:95], v[94:95], v[118:119], v[126:127]
    v_cvt_pk_bf16_f32 v108, v88, v89
    v_cvt_pk_bf16_f32 v109, v90, v91
    v_cvt_pk_bf16_f32 v110, v92, v93
    v_cvt_pk_bf16_f32 v111, v94, v95
    ds_write_b128 v6, v[108:111] offset:896
    v_mov_b32 v9, 6
    ds_write_b32 v8, v9
    v_lshrrev_b32 v11, 5, v1
    v_and_b32 v13, 3, v1
    v_bfe_u32 v14, v1, 2, 1
    v_bfe_u32 v12, v1, 3, 2
    v_lshl_add_u32 v12, v12, 2, v13
    v_lshlrev_b32 v12, 1, v12
    v_lshl_add_u32 v12, v14, 9, v12
    v_lshl_add_u32 v12, v11, 7, v12
    s_lshr_b32 s58, s56, 1
    s_lshl_b32 s59, s55, 1
    s_add_u32 s47, s58, s59
    s_lshl_b32 s58, s58, 10
    s_add_u32 s58, s58, 160768
    v_add_u32 v88, s58, v12
    s_and_b32 s44, s56, 1
    s_lshr_b32 s45, s56, 1
    v_lshrrev_b32 v3, 5, v1
    v_and_b32 v2, 31, v1
    v_lshlrev_b32 v16, 4, v2
    v_mul_u32_u24 v17, 1040, v3
    v_add_u32 v16, v16, v17
    s_lshl_b32 s58, s44, 9
    v_add_u32 v16, s58, v16
    v_add_u32 v19, 33280, v16
    v_bfe_u32 v17, v1, 2, 2
    v_lshl_add_u32 v17, v3, 3, v17
    v_lshlrev_b32 v17, 7, v17
    v_bfe_u32 v12, v1, 3, 1
    v_xor_b32 v12, s45, v12
    v_lshl_add_u32 v17, v12, 6, v17
    v_bfe_u32 v12, v1, 4, 1
    v_lshl_add_u32 v17, v12, 5, v17
    v_and_b32 v13, 3, v1
    v_lshl_add_u32 v17, v13, 3, v17
    v_add_u32 v17, 66560, v17
    v_add_u32 v18, 49152, v17
    v_lshlrev_b32 v13, 4, v1
    v_and_b32 v14, 3, v1
    v_lshlrev_b32 v14, 2, v14
    v_add_u32 v14, 163360, v14
    s_mov_b32 s59, 0x4000
LW_3:
    ds_read_b32 v9, v14
    s_waitcnt lgkmcnt(0)
    v_cmp_gt_u32 vcc, 6, v9
    s_cbranch_vccz LW_3_D
    s_sub_u32 s59, s59, 1
    s_cmp_lg_u32 s59, 0
    s_cbranch_scc1 LW_3
LW_3_D:
    ds_read_u16 v96, v88 offset:0
    ds_read_u16 v97, v88 offset:32
    ds_read_u16 v98, v88 offset:64
    ds_read_u16 v99, v88 offset:96
    ds_read_u16 v100, v88 offset:256
    ds_read_u16 v101, v88 offset:288
    ds_read_u16 v102, v88 offset:320
    ds_read_u16 v103, v88 offset:352
    v_bfe_u32 v15, v1, 2, 1
    v_cmp_eq_u32 vcc, 0, v15
    s_waitcnt lgkmcnt(0)
    v_lshl_or_b32 v90, v97, 16, v96
    v_lshl_or_b32 v91, v99, 16, v98
    v_lshl_or_b32 v92, v101, 16, v100
    v_lshl_or_b32 v93, v103, 16, v102
    v_cndmask_b32 v80, 0, v90, vcc
    v_cndmask_b32_e64 v84, v90, 0, vcc
    v_cndmask_b32 v81, 0, v91, vcc
    v_cndmask_b32_e64 v85, v91, 0, vcc
    v_cndmask_b32 v82, 0, v92, vcc
    v_cndmask_b32_e64 v86, v92, 0, vcc
    v_cndmask_b32 v83, 0, v93, vcc
    v_cndmask_b32_e64 v87, v93, 0, vcc
    v_and_b32 v10, 7, v1
    v_lshlrev_b32 v10, 2, v10
    v_add_u32 v10, 163328, v10
    s_mov_b32 s59, 0x4000
LW_4:
    ds_read_b32 v9, v10
    s_waitcnt lgkmcnt(0)
    v_cmp_gt_u32 vcc, 6, v9
    s_cbranch_vccz LW_4_D
    s_sub_u32 s59, s59, 1
    s_cmp_lg_u32 s59, 0
    s_cbranch_scc1 LW_4
LW_4_D:
    s_mul_i32 s58, s56, 4352
    s_add_u32 s58, s58, 82944
    v_add_u32 v89, s58, v13
    s_cmp_eq_u32 s57, 0
    s_cbranch_scc0 P1_Q
    s_setprio 2
    ds_read_b128 v[32:35], v16 offset:0
    ds_read_b64_tr_b16 v[36:37], v17 offset:0
    ds_read_b64_tr_b16 v[38:39], v17 offset:512
    ds_read_b128 v[40:43], v16 offset:2080
    ds_read_b64_tr_b16 v[44:45], v17 offset:2048
    ds_read_b64_tr_b16 v[46:47], v17 offset:2560
    ds_read_b128 v[48:51], v16 offset:4160
    ds_read_b64_tr_b16 v[52:53], v17 offset:4096
    ds_read_b64_tr_b16 v[54:55], v17 offset:4608
    ds_read_b128 v[56:59], v16 offset:6240
    ds_read_b64_tr_b16 v[60:61], v17 offset:6144
    ds_read_b64_tr_b16 v[62:63], v17 offset:6656
    s_waitcnt lgkmcnt(9)
    v_mfma_f32_32x32x16_bf16 v[96:111], v[36:39], v[32:35], 0
    ds_read_b128 v[64:67], v16 offset:8320
    ds_read_b64_tr_b16 v[68:69], v17 offset:8192
    ds_read_b64_tr_b16 v[70:71], v17 offset:8704
    s_waitcnt lgkmcnt(9)
    v_mfma_f32_32x32x16_bf16 v[96:111], v[44:47], v[40:43], v[96:111]
    ds_read_b128 v[72:75], v16 offset:10400
    ds_read_b64_tr_b16 v[76:77], v17 offset:10240
    ds_read_b64_tr_b16 v[78:79], v17 offset:10752
    s_waitcnt lgkmcnt(9)
    v_mfma_f32_32x32x16_bf16 v[96:111], v[52:55], v[48:51], v[96:111]
    ds_read_b128 v[32:35], v16 offset:12480
    ds_read_b64_tr_b16 v[36:37], v17 offset:12288
    ds_read_b64_tr_b16 v[38:39], v17 offset:12800
    s_waitcnt lgkmcnt(9)
    v_mfma_f32_32x32x16_bf16 v[96:111], v[60:63], v[56:59], v[96:111]
    ds_read_b128 v[40:43], v16 offset:14560
    ds_read_b64_tr_b16 v[44:45], v17 offset:14336
    ds_read_b64_tr_b16 v[46:47], v17 offset:14848
    v_mov_b32 v9, 8
    ds_write_b32 v8, v9
    s_waitcnt lgkmcnt(10)
    v_mfma_f32_32x32x16_bf16 v[96:111], v[68:71], v[64:67], v[96:111]
    ds_read_b128 v[48:51], v16 offset:16640
    ds_read_b64_tr_b16 v[52:53], v17 offset:16384
    ds_read_b64_tr_b16 v[54:55], v17 offset:16896
    s_waitcnt lgkmcnt(10)
    v_mfma_f32_32x32x16_bf16 v[96:111], v[76:79], v[72:75], v[96:111]
    ds_read_b128 v[56:59], v16 offset:18720
    ds_read_b64_tr_b16 v[60:61], v17 offset:18432
    ds_read_b64_tr_b16 v[62:63], v17 offset:18944
    s_waitcnt lgkmcnt(10)
    v_mfma_f32_32x32x16_bf16 v[96:111], v[36:39], v[32:35], v[96:111]
    ds_read_b128 v[64:67], v16 offset:20800
    ds_read_b64_tr_b16 v[68:69], v17 offset:20480
    ds_read_b64_tr_b16 v[70:71], v17 offset:20992
    s_waitcnt lgkmcnt(10)
    v_mfma_f32_32x32x16_bf16 v[96:111], v[44:47], v[40:43], v[96:111]
    ds_read_b128 v[72:75], v16 offset:22880
    ds_read_b64_tr_b16 v[76:77], v17 offset:22528
    ds_read_b64_tr_b16 v[78:79], v17 offset:23040
    s_waitcnt lgkmcnt(9)
    v_mfma_f32_32x32x16_bf16 v[96:111], v[52:55], v[48:51], v[96:111]
    ds_read_b128 v[32:35], v16 offset:24960
    ds_read_b64_tr_b16 v[36:37], v17 offset:24576
    ds_read_b64_tr_b16 v[38:39], v17 offset:25088
    s_waitcnt lgkmcnt(9)
    v_mfma_f32_32x32x16_bf16 v[96:111], v[60:63], v[56:59], v[96:111]
    ds_read_b128 v[40:43], v16 offset:27040
    ds_read_b64_tr_b16 v[44:45], v17 offset:26624
    ds_read_b64_tr_b16 v[46:47], v17 offset:27136
    s_waitcnt lgkmcnt(9)
    v_mfma_f32_32x32x16_bf16 v[96:111], v[68:71], v[64:67], v[96:111]
    ds_read_b128 v[48:51], v16 offset:29120
    ds_read_b64_tr_b16 v[52:53], v17 offset:28672
    ds_read_b64_tr_b16 v[54:55], v17 offset:29184
    s_waitcnt lgkmcnt(9)
    v_mfma_f32_32x32x16_bf16 v[96:111], v[76:79], v[72:75], v[96:111]
    ds_read_b128 v[56:59], v16 offset:31200
    ds_read_b64_tr_b16 v[60:61], v17 offset:30720
    ds_read_b64_tr_b16 v[62:63], v17 offset:31232
    v_mov_b32 v9, 10
    ds_write_b32 v8, v9
    s_waitcnt lgkmcnt(10)
    v_mfma_f32_32x32x16_bf16 v[96:111], v[36:39], v[32:35], v[96:111]
    ds_read_b128 v[64:67], v19 offset:0
    ds_read_b64_tr_b16 v[68:69], v17 offset:32768
    ds_read_b64_tr_b16 v[70:71], v17 offset:33280
    s_waitcnt lgkmcnt(10)
    v_mfma_f32_32x32x16_bf16 v[96:111], v[44:47], v[40:43], v[96:111]
    ds_read_b128 v[72:75], v19 offset:2080
    ds_read_b64_tr_b16 v[76:77], v17 offset:34816
    ds_read_b64_tr_b16 v[78:79], v17 offset:35328
    s_waitcnt lgkmcnt(10)
    v_mfma_f32_32x32x16_bf16 v[96:111], v[52:55], v[48:51], v[96:111]
    ds_read_b128 v[32:35], v19 offset:4160
    ds_read_b64_tr_b16 v[36:37], v17 offset:36864
    ds_read_b64_tr_b16 v[38:39], v17 offset:37376
    s_waitcnt lgkmcnt(10)
    v_mfma_f32_32x32x16_bf16 v[96:111], v[60:63], v[56:59], v[96:111]
    ds_read_b128 v[40:43], v19 offset:6240
    ds_read_b64_tr_b16 v[44:45], v17 offset:38912
    ds_read_b64_tr_b16 v[46:47], v17 offset:39424
    s_waitcnt lgkmcnt(9)
    v_mfma_f32_32x32x16_bf16 v[96:111], v[68:71], v[64:67], v[96:111]
    ds_read_b128 v[48:51], v19 offset:8320
    ds_read_b64_tr_b16 v[52:53], v17 offset:40960
    ds_read_b64_tr_b16 v[54:55], v17 offset:41472
    s_waitcnt lgkmcnt(9)
    v_mfma_f32_32x32x16_bf16 v[96:111], v[76:79], v[72:75], v[96:111]
    ds_read_b128 v[56:59], v19 offset:10400
    ds_read_b64_tr_b16 v[60:61], v17 offset:43008
    ds_read_b64_tr_b16 v[62:63], v17 offset:43520
    ds_read_b32 v15, v14
    s_waitcnt lgkmcnt(10)
    v_mfma_f32_32x32x16_bf16 v[96:111], v[36:39], v[32:35], v[96:111]
    ds_read_b128 v[64:67], v19 offset:12480
    ds_read_b64_tr_b16 v[68:69], v17 offset:45056
    ds_read_b64_tr_b16 v[70:71], v17 offset:45568
    s_waitcnt lgkmcnt(10)
    v_mfma_f32_32x32x16_bf16 v[96:111], v[44:47], v[40:43], v[96:111]
    ds_read_b128 v[72:75], v19 offset:14560
    ds_read_b64_tr_b16 v[76:77], v17 offset:47104
    ds_read_b64_tr_b16 v[78:79], v17 offset:47616
    v_mov_b32 v9, 12
    ds_write_b32 v8, v9
    s_waitcnt lgkmcnt(7)
    v_cmp_gt_u32 vcc, 7, v15
    s_cbranch_vccz CK_5
    s_mov_b32 s59, 0x4000
LW_6:
    ds_read_b32 v9, v14
    s_waitcnt lgkmcnt(0)
    v_cmp_gt_u32 vcc, 7, v9
    s_cbranch_vccz LW_6_D
    s_sub_u32 s59, s59, 1
    s_cmp_lg_u32 s59, 0
    s_cbranch_scc1 LW_6
LW_6_D:
CK_5:
    s_waitcnt lgkmcnt(11)
    v_mfma_f32_32x32x16_bf16 v[96:111], v[52:55], v[48:51], v[96:111]
    ds_read_b128 v[32:35], v19 offset:16640
    ds_read_b64_tr_b16 v[36:37], v18 offset:0
    ds_read_b64_tr_b16 v[38:39], v18 offset:512
    s_waitcnt lgkmcnt(11)
    v_mfma_f32_32x32x16_bf16 v[96:111], v[60:63], v[56:59], v[96:111]
    ds_read_b128 v[40:43], v19 offset:18720
    ds_read_b64_tr_b16 v[44:45], v18 offset:2048
    ds_read_b64_tr_b16 v[46:47], v18 offset:2560
    ds_read_b32 v15, v14
    s_waitcnt lgkmcnt(11)
    v_mfma_f32_32x32x16_bf16 v[96:111], v[68:71], v[64:67], v[96:111]
    ds_read_b128 v[48:51], v19 offset:20800
    ds_read_b64_tr_b16 v[52:53], v18 offset:4096
    ds_read_b64_tr_b16 v[54:55], v18 offset:4608
    s_waitcnt lgkmcnt(11)
    v_mfma_f32_32x32x16_bf16 v[96:111], v[76:79], v[72:75], v[96:111]
    ds_read_b128 v[56:59], v19 offset:22880
    ds_read_b64_tr_b16 v[60:61], v18 offset:6144
    ds_read_b64_tr_b16 v[62:63], v18 offset:6656
    s_waitcnt lgkmcnt(6)
    v_cmp_gt_u32 vcc, 8, v15
    s_cbranch_vccz CK_7
    s_mov_b32 s59, 0x4000
LW_8:
    ds_read_b32 v9, v14
    s_waitcnt lgkmcnt(0)
    v_cmp_gt_u32 vcc, 8, v9
    s_cbranch_vccz LW_8_D
    s_sub_u32 s59, s59, 1
    s_cmp_lg_u32 s59, 0
    s_cbranch_scc1 LW_8
LW_8_D:
CK_7:
    s_waitcnt lgkmcnt(10)
    v_mfma_f32_32x32x16_bf16 v[96:111], v[36:39], v[32:35], v[96:111]
    ds_read_b128 v[64:67], v19 offset:24960
    ds_read_b64_tr_b16 v[68:69], v18 offset:8192
    ds_read_b64_tr_b16 v[70:71], v18 offset:8704
    s_waitcnt lgkmcnt(10)
    v_mfma_f32_32x32x16_bf16 v[96:111], v[44:47], v[40:43], v[96:111]
    ds_read_b128 v[72:75], v19 offset:27040
    ds_read_b64_tr_b16 v[76:77], v18 offset:10240
    ds_read_b64_tr_b16 v[78:79], v18 offset:10752
    s_waitcnt lgkmcnt(9)
    v_mfma_f32_32x32x16_bf16 v[96:111], v[52:55], v[48:51], v[96:111]
    ds_read_b128 v[32:35], v19 offset:29120
    ds_read_b64_tr_b16 v[36:37], v18 offset:12288
    ds_read_b64_tr_b16 v[38:39], v18 offset:12800
    s_waitcnt lgkmcnt(9)
    v_mfma_f32_32x32x16_bf16 v[96:111], v[60:63], v[56:59], v[96:111]
    ds_read_b128 v[40:43], v19 offset:31200
    ds_read_b64_tr_b16 v[44:45], v18 offset:14336
    ds_read_b64_tr_b16 v[46:47], v18 offset:14848
    v_mov_b32 v9, 14
    ds_write_b32 v8, v9
    s_waitcnt lgkmcnt(10)
    v_mfma_f32_32x32x16_bf16 v[96:111], v[68:71], v[64:67], v[96:111]
    s_waitcnt lgkmcnt(7)
    v_mfma_f32_32x32x16_bf16 v[96:111], v[76:79], v[72:75], v[96:111]
    s_waitcnt lgkmcnt(4)
    v_mfma_f32_32x32x16_bf16 v[96:111], v[36:39], v[32:35], v[96:111]
    s_waitcnt lgkmcnt(1)
    v_mfma_f32_32x32x16_bf16 v[96:111], v[44:47], v[40:43], v[96:111]
    s_branch P1_SM
P1_Q:
    s_setprio 1
    s_mov_b32 s59, 0x4000
LW_9:
    ds_read_b32 v9, v14
    s_waitcnt lgkmcnt(0)
    v_cmp_gt_u32 vcc, 9, v9
    s_cbranch_vccz LW_9_D
    s_sub_u32 s59, s59, 1
    s_cmp_lg_u32 s59, 0
    s_cbranch_scc1 LW_9
LW_9_D:
    ds_read_b128 v[32:35], v16 offset:0
    ds_read_b64_tr_b16 v[36:37], v18 offset:16384
    ds_read_b64_tr_b16 v[38:39], v18 offset:16896
    ds_read_b128 v[40:43], v16 offset:2080
    ds_read_b64_tr_b16 v[44:45], v18 offset:18432
    ds_read_b64_tr_b16 v[46:47], v18 offset:18944
    ds_read_b128 v[48:51], v16 offset:4160
    ds_read_b64_tr_b16 v[52:53], v18 offset:20480
    ds_read_b64_tr_b16 v[54:55], v18 offset:20992
    ds_read_b128 v[56:59], v16 offset:6240
    ds_read_b64_tr_b16 v[60:61], v18 offset:22528
    ds_read_b64_tr_b16 v[62:63], v18 offset:23040
    ds_read_b32 v15, v14
    s_waitcnt lgkmcnt(0)
    v_cmp_gt_u32 vcc, 10, v15
    s_cbranch_vccz CK_10
    s_mov_b32 s59, 0x4000
LW_11:
    ds_read_b32 v9, v14
    s_waitcnt lgkmcnt(0)
    v_cmp_gt_u32 vcc, 10, v9
    s_cbranch_vccz LW_11_D
    s_sub_u32 s59, s59, 1
    s_cmp_lg_u32 s59, 0
    s_cbranch_scc1 LW_11
LW_11_D:
CK_10:
    s_waitcnt lgkmcnt(10)
    v_mfma_f32_32x32x16_bf16 v[112:127], v[32:35], v[36:39], 0
    ds_read_b128 v[64:67], v16 offset:8320
    ds_read_b64_tr_b16 v[68:69], v18 offset:24576
    ds_read_b64_tr_b16 v[70:71], v18 offset:25088
    s_waitcnt lgkmcnt(10)
    v_mfma_f32_32x32x16_bf16 v[112:127], v[40:43], v[44:47], v[112:127]
    ds_read_b128 v[72:75], v16 offset:10400
    ds_read_b64_tr_b16 v[76:77], v18 offset:26624
    ds_read_b64_tr_b16 v[78:79], v18 offset:27136
    ds_read_b32 v15, v14
    s_waitcnt lgkmcnt(11)
    v_mfma_f32_32x32x16_bf16 v[112:127], v[48:51], v[52:55], v[112:127]
    ds_read_b128 v[32:35], v16 offset:12480
    ds_read_b64_tr_b16 v[36:37], v18 offset:28672
    ds_read_b64_tr_b16 v[38:39], v18 offset:29184
    s_waitcnt lgkmcnt(11)
    v_mfma_f32_32x32x16_bf16 v[112:127], v[56:59], v[60:63], v[112:127]
    ds_read_b128 v[40:43], v16 offset:14560
    ds_read_b64_tr_b16 v[44:45], v18 offset:30720
    ds_read_b64_tr_b16 v[46:47], v18 offset:31232
    v_mov_b32 v9, 8
    ds_write_b32 v8, v9
    s_waitcnt lgkmcnt(7)
    v_cmp_gt_u32 vcc, 11, v15
    s_cbranch_vccz CK_12
    s_mov_b32 s59, 0x4000
LW_13:
    ds_read_b32 v9, v14
    s_waitcnt lgkmcnt(0)
    v_cmp_gt_u32 vcc, 11, v9
    s_cbranch_vccz LW_13_D
    s_sub_u32 s59, s59, 1
    s_cmp_lg_u32 s59, 0
    s_cbranch_scc1 LW_13
LW_13_D:
CK_12:
    s_waitcnt lgkmcnt(11)
    v_mfma_f32_32x32x16_bf16 v[112:127], v[64:67], v[68:71], v[112:127]
    ds_read_b128 v[48:51], v16 offset:16640
    ds_read_b64_tr_b16 v[52:53], v18 offset:32768
    ds_read_b64_tr_b16 v[54:55], v18 offset:33280
    s_waitcnt lgkmcnt(11)
    v_mfma_f32_32x32x16_bf16 v[112:127], v[72:75], v[76:79], v[112:127]
    ds_read_b128 v[56:59], v16 offset:18720
    ds_read_b64_tr_b16 v[60:61], v18 offset:34816
    ds_read_b64_tr_b16 v[62:63], v18 offset:35328
    ds_read_b32 v15, v14
    s_waitcnt lgkmcnt(11)
    v_mfma_f32_32x32x16_bf16 v[112:127], v[32:35], v[36:39], v[112:127]
    ds_read_b128 v[64:67], v16 offset:20800
    ds_read_b64_tr_b16 v[68:69], v18 offset:36864
    ds_read_b64_tr_b16 v[70:71], v18 offset:37376
    s_waitcnt lgkmcnt(11)
    v_mfma_f32_32x32x16_bf16 v[112:127], v[40:43], v[44:47], v[112:127]
    ds_read_b128 v[72:75], v16 offset:22880
    ds_read_b64_tr_b16 v[76:77], v18 offset:38912
    ds_read_b64_tr_b16 v[78:79], v18 offset:39424
    s_waitcnt lgkmcnt(6)
    v_cmp_gt_u32 vcc, 12, v15
    s_cbranch_vccz CK_14
    s_mov_b32 s59, 0x4000
LW_15:
    ds_read_b32 v9, v14
    s_waitcnt lgkmcnt(0)
    v_cmp_gt_u32 vcc, 12, v9
    s_cbranch_vccz LW_15_D
    s_sub_u32 s59, s59, 1
    s_cmp_lg_u32 s59, 0
    s_cbranch_scc1 LW_15
LW_15_D:
CK_14:
    s_waitcnt lgkmcnt(10)
    v_mfma_f32_32x32x16_bf16 v[112:127], v[48:51], v[52:55], v[112:127]
    ds_read_b128 v[32:35], v16 offset:24960
    ds_read_b64_tr_b16 v[36:37], v17 offset:0
    ds_read_b64_tr_b16 v[38:39], v17 offset:512
    s_waitcnt lgkmcnt(10)
    v_mfma_f32_32x32x16_bf16 v[112:127], v[56:59], v[60:63], v[112:127]
    ds_read_b128 v[40:43], v16 offset:27040
    ds_read_b64_tr_b16 v[44:45], v17 offset:2048
    ds_read_b64_tr_b16 v[46:47], v17 offset:2560
    ds_read_b32 v15, v14
    s_waitcnt lgkmcnt(10)
    v_mfma_f32_32x32x16_bf16 v[112:127], v[64:67], v[68:71], v[112:127]
    ds_read_b128 v[48:51], v16 offset:29120
    ds_read_b64_tr_b16 v[52:53], v17 offset:4096
    ds_read_b64_tr_b16 v[54:55], v17 offset:4608
    s_waitcnt lgkmcnt(10)
    v_mfma_f32_32x32x16_bf16 v[112:127], v[72:75], v[76:79], v[112:127]
    ds_read_b128 v[56:59], v16 offset:31200
    ds_read_b64_tr_b16 v[60:61], v17 offset:6144
    ds_read_b64_tr_b16 v[62:63], v17 offset:6656
    v_mov_b32 v9, 10
    ds_write_b32 v8, v9
    s_waitcnt lgkmcnt(7)
    v_cmp_gt_u32 vcc, 13, v15
    s_cbranch_vccz CK_16
    s_mov_b32 s59, 0x4000
LW_17:
    ds_read_b32 v9, v14
    s_waitcnt lgkmcnt(0)
    v_cmp_gt_u32 vcc, 13, v9
    s_cbranch_vccz LW_17_D
    s_sub_u32 s59, s59, 1
    s_cmp_lg_u32 s59, 0
    s_cbranch_scc1 LW_17
LW_17_D:
CK_16:
    s_waitcnt lgkmcnt(11)
    v_mfma_f32_32x32x16_bf16 v[112:127], v[32:35], v[36:39], v[112:127]
    ds_read_b128 v[64:67], v19 offset:0
    ds_read_b64_tr_b16 v[68:69], v17 offset:8192
    ds_read_b64_tr_b16 v[70:71], v17 offset:8704
    s_waitcnt lgkmcnt(11)
    v_mfma_f32_32x32x16_bf16 v[112:127], v[40:43], v[44:47], v[112:127]
    ds_read_b128 v[72:75], v19 offset:2080
    ds_read_b64_tr_b16 v[76:77], v17 offset:10240
    ds_read_b64_tr_b16 v[78:79], v17 offset:10752
    ds_read_b32 v15, v14
    s_waitcnt lgkmcnt(11)
    v_mfma_f32_32x32x16_bf16 v[112:127], v[48:51], v[52:55], v[112:127]
    ds_read_b128 v[32:35], v19 offset:4160
    ds_read_b64_tr_b16 v[36:37], v17 offset:12288
    ds_read_b64_tr_b16 v[38:39], v17 offset:12800
    s_waitcnt lgkmcnt(11)
    v_mfma_f32_32x32x16_bf16 v[112:127], v[56:59], v[60:63], v[112:127]
    ds_read_b128 v[40:43], v19 offset:6240
    ds_read_b64_tr_b16 v[44:45], v17 offset:14336
    ds_read_b64_tr_b16 v[46:47], v17 offset:14848
    v_mov_b32 v9, 11
    ds_write_b32 v8, v9
    s_waitcnt lgkmcnt(7)
    v_cmp_gt_u32 vcc, 14, v15
    s_cbranch_vccz CK_18
    s_mov_b32 s59, 0x4000
LW_19:
    ds_read_b32 v9, v14
    s_waitcnt lgkmcnt(0)
    v_cmp_gt_u32 vcc, 14, v9
    s_cbranch_vccz LW_19_D
    s_sub_u32 s59, s59, 1
    s_cmp_lg_u32 s59, 0
    s_cbranch_scc1 LW_19
LW_19_D:
CK_18:
    s_waitcnt lgkmcnt(11)
    v_mfma_f32_32x32x16_bf16 v[112:127], v[64:67], v[68:71], v[112:127]
    ds_read_b128 v[48:51], v19 offset:8320
    ds_read_b64_tr_b16 v[52:53], v17 offset:16384
    ds_read_b64_tr_b16 v[54:55], v17 offset:16896
    s_waitcnt lgkmcnt(11)
    v_mfma_f32_32x32x16_bf16 v[112:127], v[72:75], v[76:79], v[112:127]
    ds_read_b128 v[56:59], v19 offset:10400
    ds_read_b64_tr_b16 v[60:61], v17 offset:18432
    ds_read_b64_tr_b16 v[62:63], v17 offset:18944
    ds_read_b32 v15, v14
    s_waitcnt lgkmcnt(11)
    v_mfma_f32_32x32x16_bf16 v[112:127], v[32:35], v[36:39], v[112:127]
    ds_read_b128 v[64:67], v19 offset:12480
    ds_read_b64_tr_b16 v[68:69], v17 offset:20480
    ds_read_b64_tr_b16 v[70:71], v17 offset:20992
    s_waitcnt lgkmcnt(11)
    v_mfma_f32_32x32x16_bf16 v[112:127], v[40:43], v[44:47], v[112:127]
    ds_read_b128 v[72:75], v19 offset:14560
    ds_read_b64_tr_b16 v[76:77], v17 offset:22528
    ds_read_b64_tr_b16 v[78:79], v17 offset:23040
    s_waitcnt lgkmcnt(6)
    v_cmp_gt_u32 vcc, 15, v15
    s_cbranch_vccz CK_20
    s_mov_b32 s59, 0x4000
LW_21:
    ds_read_b32 v9, v14
    s_waitcnt lgkmcnt(0)
    v_cmp_gt_u32 vcc, 15, v9
    s_cbranch_vccz LW_21_D
    s_sub_u32 s59, s59, 1
    s_cmp_lg_u32 s59, 0
    s_cbranch_scc1 LW_21
LW_21_D:
CK_20:
    s_waitcnt lgkmcnt(10)
    v_mfma_f32_32x32x16_bf16 v[112:127], v[48:51], v[52:55], v[112:127]
    ds_read_b128 v[32:35], v19 offset:16640
    ds_read_b64_tr_b16 v[36:37], v17 offset:24576
    ds_read_b64_tr_b16 v[38:39], v17 offset:25088
    s_waitcnt lgkmcnt(10)
    v_mfma_f32_32x32x16_bf16 v[112:127], v[56:59], v[60:63], v[112:127]
    ds_read_b128 v[40:43], v19 offset:18720
    ds_read_b64_tr_b16 v[44:45], v17 offset:26624
    ds_read_b64_tr_b16 v[46:47], v17 offset:27136
    ds_read_b32 v15, v14
    s_waitcnt lgkmcnt(10)
    v_mfma_f32_32x32x16_bf16 v[112:127], v[64:67], v[68:71], v[112:127]
    ds_read_b128 v[48:51], v19 offset:20800
    ds_read_b64_tr_b16 v[52:53], v17 offset:28672
    ds_read_b64_tr_b16 v[54:55], v17 offset:29184
    s_waitcnt lgkmcnt(10)
    v_mfma_f32_32x32x16_bf16 v[112:127], v[72:75], v[76:79], v[112:127]
    ds_read_b128 v[56:59], v19 offset:22880
    ds_read_b64_tr_b16 v[60:61], v17 offset:30720
    ds_read_b64_tr_b16 v[62:63], v17 offset:31232
    s_waitcnt lgkmcnt(6)
    v_cmp_gt_u32 vcc, 16, v15
    s_cbranch_vccz CK_22
    s_mov_b32 s59, 0x4000
LW_23:
    ds_read_b32 v9, v14
    s_waitcnt lgkmcnt(0)
    v_cmp_gt_u32 vcc, 16, v9
    s_cbranch_vccz LW_23_D
    s_sub_u32 s59, s59, 1
    s_cmp_lg_u32 s59, 0
    s_cbranch_scc1 LW_23
LW_23_D:
CK_22:
    s_waitcnt lgkmcnt(10)
    v_mfma_f32_32x32x16_bf16 v[112:127], v[32:35], v[36:39], v[112:127]
    ds_read_b128 v[64:67], v19 offset:24960
    ds_read_b64_tr_b16 v[68:69], v17 offset:32768
    ds_read_b64_tr_b16 v[70:71], v17 offset:33280
    s_waitcnt lgkmcnt(10)
    v_mfma_f32_32x32x16_bf16 v[112:127], v[40:43], v[44:47], v[112:127]
    ds_read_b128 v[72:75], v19 offset:27040
    ds_read_b64_tr_b16 v[76:77], v17 offset:34816
    ds_read_b64_tr_b16 v[78:79], v17 offset:35328
    s_waitcnt lgkmcnt(9)
    v_mfma_f32_32x32x16_bf16 v[112:127], v[48:51], v[52:55], v[112:127]
    ds_read_b128 v[32:35], v19 offset:29120
    ds_read_b64_tr_b16 v[36:37], v17 offset:36864
    ds_read_b64_tr_b16 v[38:39], v17 offset:37376
    s_waitcnt lgkmcnt(9)
    v_mfma_f32_32x32x16_bf16 v[112:127], v[56:59], v[60:63], v[112:127]
    ds_read_b128 v[40:43], v19 offset:31200
    ds_read_b64_tr_b16 v[44:45], v17 offset:38912
    ds_read_b64_tr_b16 v[46:47], v17 offset:39424
    v_mov_b32 v9, 14
    ds_write_b32 v8, v9
    s_waitcnt lgkmcnt(10)
    v_mfma_f32_32x32x16_bf16 v[112:127], v[64:67], v[68:71], v[112:127]
    s_waitcnt lgkmcnt(7)
    v_mfma_f32_32x32x16_bf16 v[112:127], v[72:75], v[76:79], v[112:127]
    s_waitcnt lgkmcnt(4)
    v_mfma_f32_32x32x16_bf16 v[112:127], v[32:35], v[36:39], v[112:127]
    s_waitcnt lgkmcnt(1)
    v_mfma_f32_32x32x16_bf16 v[112:127], v[40:43], v[44:47], v[112:127]
    v_and_b32 v10, 3, v1
    v_lshlrev_b32 v10, 2, v10
    v_add_u32 v10, 163344, v10
    s_mov_b32 s59, 0x4000
LW_24:
    ds_read_b32 v9, v10
    s_waitcnt lgkmcnt(0)
    v_cmp_gt_u32 vcc, 14, v9
    s_cbranch_vccz LW_24_D
    s_sub_u32 s59, s59, 1
    s_cmp_lg_u32 s59, 0
    s_cbranch_scc1 LW_24
LW_24_D:
    s_nop 7
    v_cvt_pk_bf16_f32 v24, v112, v113
    v_cvt_pk_bf16_f32 v25, v114, v115
    v_cvt_pk_bf16_f32 v26, v116, v117
    v_cvt_pk_bf16_f32 v27, v118, v119
    v_cvt_pk_bf16_f32 v28, v120, v121
    v_cvt_pk_bf16_f32 v29, v122, v123
    v_cvt_pk_bf16_f32 v30, v124, v125
    v_cvt_pk_bf16_f32 v31, v126, v127
    ds_write_b128 v89, v[24:27]
    ds_write_b128 v89, v[28:31] offset:1024
    v_mov_b32 v9, 15
    ds_write_b32 v8, v9
    s_setprio 0
    s_mov_b32 s59, 0x4000
LW_25:
    ds_read_b32 v9, v14
    s_waitcnt lgkmcnt(0)
    v_cmp_gt_u32 vcc, 17, v9
    s_cbranch_vccz LW_25_D
    s_sub_u32 s59, s59, 1
    s_cmp_lg_u32 s59, 0
    s_cbranch_scc1 LW_25
LW_25_D:
    ds_read_b128 v[32:35], v16 offset:0
    ds_read_b64_tr_b16 v[36:37], v17 offset:40960
    ds_read_b64_tr_b16 v[38:39], v17 offset:41472
    ds_read_b128 v[40:43], v16 offset:2080
    ds_read_b64_tr_b16 v[44:45], v17 offset:43008
    ds_read_b64_tr_b16 v[46:47], v17 offset:43520
    ds_read_b128 v[48:51], v16 offset:4160
    ds_read_b64_tr_b16 v[52:53], v17 offset:45056
    ds_read_b64_tr_b16 v[54:55], v17 offset:45568
    ds_read_b128 v[56:59], v16 offset:6240
    ds_read_b64_tr_b16 v[60:61], v17 offset:47104
    ds_read_b64_tr_b16 v[62:63], v17 offset:47616
    ds_read_b32 v15, v14
    s_waitcnt lgkmcnt(0)
    v_cmp_gt_u32 vcc, 18, v15
    s_cbranch_vccz CK_26
    s_mov_b32 s59, 0x4000
LW_27:
    ds_read_b32 v9, v14
    s_waitcnt lgkmcnt(0)
    v_cmp_gt_u32 vcc, 18, v9
    s_cbranch_vccz LW_27_D
    s_sub_u32 s59, s59, 1
    s_cmp_lg_u32 s59, 0
    s_cbranch_scc1 LW_27
LW_27_D:
CK_26:
    s_waitcnt lgkmcnt(10)
    v_mfma_f32_32x32x16_bf16 v[96:111], v[36:39], v[32:35], 0
    ds_read_b128 v[64:67], v16 offset:8320
    ds_read_b64_tr_b16 v[68:69], v18 offset:0
    ds_read_b64_tr_b16 v[70:71], v18 offset:512
    s_waitcnt lgkmcnt(10)
    v_mfma_f32_32x32x16_bf16 v[96:111], v[44:47], v[40:43], v[96:111]
    ds_read_b128 v[72:75], v16 offset:10400
    ds_read_b64_tr_b16 v[76:77], v18 offset:2048
    ds_read_b64_tr_b16 v[78:79], v18 offset:2560
    ds_read_b32 v15, v14
    s_waitcnt lgkmcnt(11)
    v_mfma_f32_32x32x16_bf16 v[96:111], v[52:55], v[48:51], v[96:111]
    ds_read_b128 v[32:35], v16 offset:12480
    ds_read_b64_tr_b16 v[36:37], v18 offset:4096
    ds_read_b64_tr_b16 v[38:39], v18 offset:4608
    s_waitcnt lgkmcnt(11)
    v_mfma_f32_32x32x16_bf16 v[96:111], v[60:63], v[56:59], v[96:111]
    ds_read_b128 v[40:43], v16 offset:14560
    ds_read_b64_tr_b16 v[44:45], v18 offset:6144
    ds_read_b64_tr_b16 v[46:47], v18 offset:6656
    s_waitcnt lgkmcnt(6)
    v_cmp_gt_u32 vcc, 19, v15
    s_cbranch_vccz CK_28
    s_mov_b32 s59, 0x4000
LW_29:
    ds_read_b32 v9, v14
    s_waitcnt lgkmcnt(0)
    v_cmp_gt_u32 vcc, 19, v9
    s_cbranch_vccz LW_29_D
    s_sub_u32 s59, s59, 1
    s_cmp_lg_u32 s59, 0
    s_cbranch_scc1 LW_29
LW_29_D:
CK_28:
    s_waitcnt lgkmcnt(10)
    v_mfma_f32_32x32x16_bf16 v[96:111], v[68:71], v[64:67], v[96:111]
    ds_read_b128 v[48:51], v16 offset:16640
    ds_read_b64_tr_b16 v[52:53], v18 offset:8192
    ds_read_b64_tr_b16 v[54:55], v18 offset:8704
    s_waitcnt lgkmcnt(10)
    v_mfma_f32_32x32x16_bf16 v[96:111], v[76:79], v[72:75], v[96:111]
    ds_read_b128 v[56:59], v16 offset:18720
    ds_read_b64_tr_b16 v[60:61], v18 offset:10240
    ds_read_b64_tr_b16 v[62:63], v18 offset:10752
    ds_read_b32 v15, v14
    s_waitcnt lgkmcnt(10)
    v_mfma_f32_32x32x16_bf16 v[96:111], v[36:39], v[32:35], v[96:111]
    ds_read_b128 v[64:67], v16 offset:20800
    ds_read_b64_tr_b16 v[68:69], v18 offset:12288
    ds_read_b64_tr_b16 v[70:71], v18 offset:12800
    s_waitcnt lgkmcnt(10)
    v_mfma_f32_32x32x16_bf16 v[96:111], v[44:47], v[40:43], v[96:111]
    ds_read_b128 v[72:75], v16 offset:22880
    ds_read_b64_tr_b16 v[76:77], v18 offset:14336
    ds_read_b64_tr_b16 v[78:79], v18 offset:14848
    s_waitcnt lgkmcnt(6)
    v_cmp_gt_u32 vcc, 20, v15
    s_cbranch_vccz CK_30
    s_mov_b32 s59, 0x4000
LW_31:
    ds_read_b32 v9, v14
    s_waitcnt lgkmcnt(0)
    v_cmp_gt_u32 vcc, 20, v9
    s_cbranch_vccz LW_31_D
    s_sub_u32 s59, s59, 1
    s_cmp_lg_u32 s59, 0
    s_cbranch_scc1 LW_31
LW_31_D:
CK_30:
    s_waitcnt lgkmcnt(10)
    v_mfma_f32_32x32x16_bf16 v[96:111], v[52:55], v[48:51], v[96:111]
    ds_read_b128 v[32:35], v16 offset:24960
    ds_read_b64_tr_b16 v[36:37], v18 offset:16384
    ds_read_b64_tr_b16 v[38:39], v18 offset:16896
    s_waitcnt lgkmcnt(10)
    v_mfma_f32_32x32x16_bf16 v[96:111], v[60:63], v[56:59], v[96:111]
    ds_read_b128 v[40:43], v16 offset:27040
    ds_read_b64_tr_b16 v[44:45], v18 offset:18432
    ds_read_b64_tr_b16 v[46:47], v18 offset:18944
    ds_read_b32 v15, v14
    s_waitcnt lgkmcnt(10)
    v_mfma_f32_32x32x16_bf16 v[96:111], v[68:71], v[64:67], v[96:111]
    ds_read_b128 v[48:51], v16 offset:29120
    ds_read_b64_tr_b16 v[52:53], v18 offset:20480
    ds_read_b64_tr_b16 v[54:55], v18 offset:20992
    s_waitcnt lgkmcnt(10)
    v_mfma_f32_32x32x16_bf16 v[96:111], v[76:79], v[72:75], v[96:111]
    ds_read_b128 v[56:59], v16 offset:31200
    ds_read_b64_tr_b16 v[60:61], v18 offset:22528
    ds_read_b64_tr_b16 v[62:63], v18 offset:23040
    s_waitcnt lgkmcnt(6)
    v_cmp_gt_u32 vcc, 21, v15
    s_cbranch_vccz CK_32
    s_mov_b32 s59, 0x4000
LW_33:
    ds_read_b32 v9, v14
    s_waitcnt lgkmcnt(0)
    v_cmp_gt_u32 vcc, 21, v9
    s_cbranch_vccz LW_33_D
    s_sub_u32 s59, s59, 1
    s_cmp_lg_u32 s59, 0
    s_cbranch_scc1 LW_33
LW_33_D:
CK_32:
    s_waitcnt lgkmcnt(10)
    v_mfma_f32_32x32x16_bf16 v[96:111], v[36:39], v[32:35], v[96:111]
    ds_read_b128 v[64:67], v19 offset:0
    ds_read_b64_tr_b16 v[68:69], v18 offset:24576
    ds_read_b64_tr_b16 v[70:71], v18 offset:25088
    s_waitcnt lgkmcnt(10)
    v_mfma_f32_32x32x16_bf16 v[96:111], v[44:47], v[40:43], v[96:111]
    ds_read_b128 v[72:75], v19 offset:2080
    ds_read_b64_tr_b16 v[76:77], v18 offset:26624
    ds_read_b64_tr_b16 v[78:79], v18 offset:27136
    ds_read_b32 v15, v14
    s_waitcnt lgkmcnt(10)
    v_mfma_f32_32x32x16_bf16 v[96:111], v[52:55], v[48:51], v[96:111]
    ds_read_b128 v[32:35], v19 offset:4160
    ds_read_b64_tr_b16 v[36:37], v18 offset:28672
    ds_read_b64_tr_b16 v[38:39], v18 offset:29184
    s_waitcnt lgkmcnt(10)
    v_mfma_f32_32x32x16_bf16 v[96:111], v[60:63], v[56:59], v[96:111]
    ds_read_b128 v[40:43], v19 offset:6240
    ds_read_b64_tr_b16 v[44:45], v18 offset:30720
    ds_read_b64_tr_b16 v[46:47], v18 offset:31232
    s_waitcnt lgkmcnt(6)
    v_cmp_gt_u32 vcc, 22, v15
    s_cbranch_vccz CK_34
    s_mov_b32 s59, 0x4000
LW_35:
    ds_read_b32 v9, v14
    s_waitcnt lgkmcnt(0)
    v_cmp_gt_u32 vcc, 22, v9
    s_cbranch_vccz LW_35_D
    s_sub_u32 s59, s59, 1
    s_cmp_lg_u32 s59, 0
    s_cbranch_scc1 LW_35
LW_35_D:
CK_34:
    s_waitcnt lgkmcnt(10)
    v_mfma_f32_32x32x16_bf16 v[96:111], v[68:71], v[64:67], v[96:111]
    ds_read_b128 v[48:51], v19 offset:8320
    ds_read_b64_tr_b16 v[52:53], v18 offset:32768
    ds_read_b64_tr_b16 v[54:55], v18 offset:33280
    s_waitcnt lgkmcnt(10)
    v_mfma_f32_32x32x16_bf16 v[96:111], v[76:79], v[72:75], v[96:111]
    ds_read_b128 v[56:59], v19 offset:10400
    ds_read_b64_tr_b16 v[60:61], v18 offset:34816
    ds_read_b64_tr_b16 v[62:63], v18 offset:35328
    ds_read_b32 v15, v14
    s_waitcnt lgkmcnt(10)
    v_mfma_f32_32x32x16_bf16 v[96:111], v[36:39], v[32:35], v[96:111]
    ds_read_b128 v[64:67], v19 offset:12480
    ds_read_b64_tr_b16 v[68:69], v18 offset:36864
    ds_read_b64_tr_b16 v[70:71], v18 offset:37376
    s_waitcnt lgkmcnt(10)
    v_mfma_f32_32x32x16_bf16 v[96:111], v[44:47], v[40:43], v[96:111]
    ds_read_b128 v[72:75], v19 offset:14560
    ds_read_b64_tr_b16 v[76:77], v18 offset:38912
    ds_read_b64_tr_b16 v[78:79], v18 offset:39424
    s_waitcnt lgkmcnt(6)
    v_cmp_gt_u32 vcc, 23, v15
    s_cbranch_vccz CK_36
    s_mov_b32 s59, 0x4000
LW_37:
    ds_read_b32 v9, v14
    s_waitcnt lgkmcnt(0)
    v_cmp_gt_u32 vcc, 23, v9
    s_cbranch_vccz LW_37_D
    s_sub_u32 s59, s59, 1
    s_cmp_lg_u32 s59, 0
    s_cbranch_scc1 LW_37
LW_37_D:
CK_36:
    s_waitcnt lgkmcnt(10)
    v_mfma_f32_32x32x16_bf16 v[96:111], v[52:55], v[48:51], v[96:111]
    ds_read_b128 v[32:35], v19 offset:16640
    ds_read_b64_tr_b16 v[36:37], v17 offset:0
    ds_read_b64_tr_b16 v[38:39], v17 offset:512
    s_waitcnt lgkmcnt(10)
    v_mfma_f32_32x32x16_bf16 v[96:111], v[60:63], v[56:59], v[96:111]
    ds_read_b128 v[40:43], v19 offset:18720
    ds_read_b64_tr_b16 v[44:45], v17 offset:2048
    ds_read_b64_tr_b16 v[46:47], v17 offset:2560
    ds_read_b32 v15, v14
    s_waitcnt lgkmcnt(10)
    v_mfma_f32_32x32x16_bf16 v[96:111], v[68:71], v[64:67], v[96:111]
    ds_read_b128 v[48:51], v19 offset:20800
    ds_read_b64_tr_b16 v[52:53], v17 offset:4096
    ds_read_b64_tr_b16 v[54:55], v17 offset:4608
    s_waitcnt lgkmcnt(10)
    v_mfma_f32_32x32x16_bf16 v[96:111], v[76:79], v[72:75], v[96:111]
    ds_read_b128 v[56:59], v19 offset:22880
    ds_read_b64_tr_b16 v[60:61], v17 offset:6144
    ds_read_b64_tr_b16 v[62:63], v17 offset:6656
    s_waitcnt lgkmcnt(6)
    v_cmp_gt_u32 vcc, 24, v15
    s_cbranch_vccz CK_38
    s_mov_b32 s59, 0x4000
LW_39:
    ds_read_b32 v9, v14
    s_waitcnt lgkmcnt(0)
    v_cmp_gt_u32 vcc, 24, v9
    s_cbranch_vccz LW_39_D
    s_sub_u32 s59, s59, 1
    s_cmp_lg_u32 s59, 0
    s_cbranch_scc1 LW_39
LW_39_D:
CK_38:
    s_waitcnt lgkmcnt(10)
    v_mfma_f32_32x32x16_bf16 v[96:111], v[36:39], v[32:35], v[96:111]
    ds_read_b128 v[64:67], v19 offset:24960
    ds_read_b64_tr_b16 v[68:69], v17 offset:8192
    ds_read_b64_tr_b16 v[70:71], v17 offset:8704
    s_waitcnt lgkmcnt(10)
    v_mfma_f32_32x32x16_bf16 v[96:111], v[44:47], v[40:43], v[96:111]
    ds_read_b128 v[72:75], v19 offset:27040
    ds_read_b64_tr_b16 v[76:77], v17 offset:10240
    ds_read_b64_tr_b16 v[78:79], v17 offset:10752
    s_waitcnt lgkmcnt(9)
    v_mfma_f32_32x32x16_bf16 v[96:111], v[52:55], v[48:51], v[96:111]
    ds_read_b128 v[32:35], v19 offset:29120
    ds_read_b64_tr_b16 v[36:37], v17 offset:12288
    ds_read_b64_tr_b16 v[38:39], v17 offset:12800
    s_waitcnt lgkmcnt(9)
    v_mfma_f32_32x32x16_bf16 v[96:111], v[60:63], v[56:59], v[96:111]
    ds_read_b128 v[40:43], v19 offset:31200
    ds_read_b64_tr_b16 v[44:45], v17 offset:14336
    ds_read_b64_tr_b16 v[46:47], v17 offset:14848
    v_mov_b32 v9, 16
    ds_write_b32 v8, v9
    s_waitcnt lgkmcnt(10)
    v_mfma_f32_32x32x16_bf16 v[96:111], v[68:71], v[64:67], v[96:111]
    s_waitcnt lgkmcnt(7)
    v_mfma_f32_32x32x16_bf16 v[96:111], v[76:79], v[72:75], v[96:111]
    s_waitcnt lgkmcnt(4)
    v_mfma_f32_32x32x16_bf16 v[96:111], v[36:39], v[32:35], v[96:111]
    s_waitcnt lgkmcnt(1)
    v_mfma_f32_32x32x16_bf16 v[96:111], v[44:47], v[40:43], v[96:111]
P1_SM:
    s_nop 7
    s_nop 7
    s_mov_b32 s40, 0x3fb8aa3b
    s_mov_b32 s41, 0x3fb8aa3b
    s_mov_b32 s42, 0xbfb8aa3b
    s_mov_b32 s43, 0xbfb8aa3b
    v_cvt_pk_bf16_f32 v16, v96, v97
    v_cvt_pk_bf16_f32 v17, v98, v99
    v_cvt_pk_bf16_f32 v18, v100, v101
    v_cvt_pk_bf16_f32 v19, v102, v103
    v_cvt_pk_bf16_f32 v20, v104, v105
    v_cvt_pk_bf16_f32 v21, v106, v107
    v_cvt_pk_bf16_f32 v22, v108, v109
    v_cvt_pk_bf16_f32 v23, v110, v111
    v_mfma_f32_32x32x16_bf16 v[32:47], v[80:83], v[16:19], 0
    s_nop 0
    v_mfma_f32_32x32x16_bf16 v[32:47], v[84:87], v[20:23], v[32:47]
    s_nop 7
    s_nop 3
    v_cvt_pk_bf16_f32 v48, v32, v33
    v_cvt_pk_bf16_f32 v49, v34, v35
    v_cvt_pk_bf16_f32 v50, v36, v37
    v_cvt_pk_bf16_f32 v51, v38, v39
    v_cvt_pk_bf16_f32 v52, v40, v41
    v_cvt_pk_bf16_f32 v53, v42, v43
    v_cvt_pk_bf16_f32 v54, v44, v45
    v_cvt_pk_bf16_f32 v55, v46, v47
    v_lshlrev_b32 v32, 16, v48
    v_and_b32 v33, 0xffff0000, v48
    v_lshlrev_b32 v34, 16, v49
    v_and_b32 v35, 0xffff0000, v49
    v_lshlrev_b32 v36, 16, v50
    v_and_b32 v37, 0xffff0000, v50
    v_lshlrev_b32 v38, 16, v51
    v_and_b32 v39, 0xffff0000, v51
    v_lshlrev_b32 v40, 16, v52
    v_and_b32 v41, 0xffff0000, v52
    v_lshlrev_b32 v42, 16, v53
    v_and_b32 v43, 0xffff0000, v53
    v_lshlrev_b32 v44, 16, v54
    v_and_b32 v45, 0xffff0000, v54
    v_lshlrev_b32 v46, 16, v55
    v_and_b32 v47, 0xffff0000, v55
    v_max3_f32 v24, v32, v33, v34
    v_min3_f32 v26, v32, v33, v34
    v_max3_f32 v25, v35, v36, v37
    v_min3_f32 v27, v35, v36, v37
    v_max3_f32 v24, v24, v38, v39
    v_min3_f32 v26, v26, v38, v39
    v_max3_f32 v25, v25, v40, v41
    v_min3_f32 v27, v27, v40, v41
    v_max3_f32 v24, v24, v42, v43
    v_min3_f32 v26, v26, v42, v43
    v_max3_f32 v25, v25, v44, v45
    v_min3_f32 v27, v27, v44, v45
    v_max3_f32 v24, v24, v46, v47
    v_min3_f32 v26, v26, v46, v47
    v_max_f32 v24, v24, v25
    v_min_f32 v26, v26, v27
    v_mul_f32 v24, s42, v24
    v_mul_f32 v26, s40, v26
    v_mov_b32 v25, v24
    v_mov_b32 v27, v26
    v_pk_fma_f32 v[64:65], v[32:33], s[42:43], v[26:27]
    v_pk_fma_f32 v[66:67], v[34:35], s[42:43], v[26:27]
    v_pk_fma_f32 v[68:69], v[36:37], s[42:43], v[26:27]
    v_pk_fma_f32 v[70:71], v[38:39], s[42:43], v[26:27]
    v_pk_fma_f32 v[72:73], v[40:41], s[42:43], v[26:27]
    v_pk_fma_f32 v[74:75], v[42:43], s[42:43], v[26:27]
    v_pk_fma_f32 v[76:77], v[44:45], s[42:43], v[26:27]
    v_pk_fma_f32 v[78:79], v[46:47], s[42:43], v[26:27]
    v_pk_fma_f32 v[32:33], v[32:33], s[40:41], v[24:25]
    v_pk_fma_f32 v[34:35], v[34:35], s[40:41], v[24:25]
    v_pk_fma_f32 v[36:37], v[36:37], s[40:41], v[24:25]
    v_pk_fma_f32 v[38:39], v[38:39], s[40:41], v[24:25]
    v_pk_fma_f32 v[40:41], v[40:41], s[40:41], v[24:25]
    v_pk_fma_f32 v[42:43], v[42:43], s[40:41], v[24:25]
    v_pk_fma_f32 v[44:45], v[44:45], s[40:41], v[24:25]
    v_pk_fma_f32 v[46:47], v[46:47], s[40:41], v[24:25]
    v_exp_f32 v64, v64
    v_exp_f32 v65, v65
    v_exp_f32 v66, v66
    v_exp_f32 v67, v67
    v_exp_f32 v68, v68
    v_exp_f32 v69, v69
    v_exp_f32 v70, v70
    v_exp_f32 v71, v71
    v_exp_f32 v72, v72
    v_exp_f32 v73, v73
    v_exp_f32 v74, v74
    v_exp_f32 v75, v75
    v_exp_f32 v76, v76
    v_exp_f32 v77, v77
    v_exp_f32 v78, v78
    v_exp_f32 v79, v79
    v_exp_f32 v32, v32
    v_exp_f32 v33, v33
    v_exp_f32 v34, v34
    v_exp_f32 v35, v35
    v_exp_f32 v36, v36
    v_exp_f32 v37, v37
    v_exp_f32 v38, v38
    v_exp_f32 v39, v39
    v_exp_f32 v40, v40
    v_exp_f32 v41, v41
    v_exp_f32 v42, v42
    v_exp_f32 v43, v43
    v_exp_f32 v44, v44
    v_exp_f32 v45, v45
    v_exp_f32 v46, v46
    v_exp_f32 v47, v47
    v_pk_add_f32 v[28:29], v[64:65], v[66:67]
    v_pk_add_f32 v[30:31], v[68:69], v[70:71]
    v_pk_add_f32 v[28:29], v[28:29], v[72:73]
    v_pk_add_f32 v[30:31], v[30:31], v[74:75]
    v_pk_add_f32 v[28:29], v[28:29], v[76:77]
    v_pk_add_f32 v[30:31], v[30:31], v[78:79]
    v_pk_add_f32 v[28:29], v[28:29], v[30:31]
    v_add_f32 v28, v28, v29
    v_pk_add_f32 v[24:25], v[32:33], v[34:35]
    v_pk_add_f32 v[26:27], v[36:37], v[38:39]
    v_pk_add_f32 v[24:25], v[24:25], v[40:41]
    v_pk_add_f32 v[26:27], v[26:27], v[42:43]
    v_pk_add_f32 v[24:25], v[24:25], v[44:45]
    v_pk_add_f32 v[26:27], v[26:27], v[46:47]
    v_pk_add_f32 v[24:25], v[24:25], v[26:27]
    v_add_f32 v24, v24, v25
    v_rcp_f32 v28, v28
    v_rcp_f32 v24, v24
    v_mov_b32 v29, v28
    v_mov_b32 v25, v24
    v_pk_mul_f32 v[64:65], v[64:65], v[28:29]
    v_pk_mul_f32 v[66:67], v[66:67], v[28:29]
    v_pk_mul_f32 v[68:69], v[68:69], v[28:29]
    v_pk_mul_f32 v[70:71], v[70:71], v[28:29]
    v_pk_mul_f32 v[72:73], v[72:73], v[28:29]
    v_pk_mul_f32 v[74:75], v[74:75], v[28:29]
    v_pk_mul_f32 v[76:77], v[76:77], v[28:29]
    v_pk_mul_f32 v[78:79], v[78:79], v[28:29]
    v_pk_mul_f32 v[32:33], v[32:33], v[24:25]
    v_pk_mul_f32 v[34:35], v[34:35], v[24:25]
    v_pk_mul_f32 v[36:37], v[36:37], v[24:25]
    v_pk_mul_f32 v[38:39], v[38:39], v[24:25]
    v_pk_mul_f32 v[40:41], v[40:41], v[24:25]
    v_pk_mul_f32 v[42:43], v[42:43], v[24:25]
    v_pk_mul_f32 v[44:45], v[44:45], v[24:25]
    v_pk_mul_f32 v[46:47], v[46:47], v[24:25]
    v_cvt_pk_bf16_f32 v56, v64, v65
    v_cvt_pk_bf16_f32 v57, v66, v67
    v_cvt_pk_bf16_f32 v58, v68, v69
    v_cvt_pk_bf16_f32 v59, v70, v71
    v_cvt_pk_bf16_f32 v60, v72, v73
    v_cvt_pk_bf16_f32 v61, v74, v75
    v_cvt_pk_bf16_f32 v62, v76, v77
    v_cvt_pk_bf16_f32 v63, v78, v79
    v_cvt_pk_bf16_f32 v48, v32, v33
    v_cvt_pk_bf16_f32 v49, v34, v35
    v_cvt_pk_bf16_f32 v50, v36, v37
    v_cvt_pk_bf16_f32 v51, v38, v39
    v_cvt_pk_bf16_f32 v52, v40, v41
    v_cvt_pk_bf16_f32 v53, v42, v43
    v_cvt_pk_bf16_f32 v54, v44, v45
    v_cvt_pk_bf16_f32 v55, v46, v47
    s_add_u32 s36, s28, 0xe80000
    s_addc_u32 s37, s29, 0
    s_mov_b32 s38, 0x22000
    s_mov_b32 s39, 0x00020000
    s_cmp_eq_u32 s57, 0
    s_cbranch_scc0 P1_QT
    v_mov_b32 v113, v89
    v_and_b32 v15, 1, v1
    v_lshlrev_b32 v15, 4, v15
    v_mov_b32 v14, 0x3f80
    v_lshlrev_b32 v14, v15, v14
    v_cmp_eq_u32 vcc, v12, v3
    s_nop 1
    v_cndmask_b32 v14, 0, v14, vcc
    v_bfe_u32 v15, v1, 1, 3
    v_cmp_eq_u32 vcc, 0, v15
    s_nop 1
    v_cndmask_b32 v16, 0, v14, vcc
    v_cmp_eq_u32 vcc, 1, v15
    s_nop 1
    v_cndmask_b32 v17, 0, v14, vcc
    v_cmp_eq_u32 vcc, 2, v15
    s_nop 1
    v_cndmask_b32 v18, 0, v14, vcc
    v_cmp_eq_u32 vcc, 3, v15
    s_nop 1
    v_cndmask_b32 v19, 0, v14, vcc
    v_cmp_eq_u32 vcc, 4, v15
    s_nop 1
    v_cndmask_b32 v20, 0, v14, vcc
    v_cmp_eq_u32 vcc, 5, v15
    s_nop 1
    v_cndmask_b32 v21, 0, v14, vcc
    v_cmp_eq_u32 vcc, 6, v15
    s_nop 1
    v_cndmask_b32 v22, 0, v14, vcc
    v_cmp_eq_u32 vcc, 7, v15
    s_nop 1
    v_cndmask_b32 v23, 0, v14, vcc
    v_mfma_f32_32x32x16_bf16 v[64:79], v[48:51], v[16:19], 0
    v_mfma_f32_32x32x16_bf16 v[80:95], v[56:59], v[16:19], 0
    v_mfma_f32_32x32x16_bf16 v[64:79], v[52:55], v[20:23], v[64:79]
    v_mfma_f32_32x32x16_bf16 v[80:95], v[60:63], v[20:23], v[80:95]
    s_mul_i32 s58, s56, 4352
    s_add_u32 s58, s58, 82944
    v_mul_u32_u24 v14, 2176, v12
    v_add_u32 v14, s58, v14
    v_and_b32 v15, 15, v1
    v_lshl_add_u32 v4, v15, 5, v14
    v_mul_u32_u24 v5, 544, v3
    v_add_u32 v4, v4, v5
    v_bfe_u32 v5, v1, 2, 1
    v_mul_u32_u24 v5, 544, v5
    v_add_u32 v14, v14, v5
    v_bfe_u32 v5, v1, 3, 1
    v_lshl_add_u32 v14, v5, 4, v14
    v_and_b32 v5, 3, v1
    v_lshl_add_u32 v14, v5, 2, v14
    s_lshl_b32 s58, s3, 2
    s_add_u32 s58, s58, 163344
    v_mov_b32 v10, s58
    v_mov_b32 v5, v113
    s_mov_b32 s59, 0x4000
LW_40:
    ds_read_b32 v9, v10
    s_waitcnt lgkmcnt(0)
    v_cmp_gt_u32 vcc, 15, v9
    s_cbranch_vccz LW_40_D
    s_sub_u32 s59, s59, 1
    s_cmp_lg_u32 s59, 0
    s_cbranch_scc1 LW_40
LW_40_D:
    ds_read_b128 v[24:27], v5
    ds_read_b128 v[28:31], v5 offset:1024
    v_cmp_eq_u32 vcc, 0, v12
    v_cvt_pk_bf16_f32 v32, v64, v65
    v_cvt_pk_bf16_f32 v33, v66, v67
    v_cvt_pk_bf16_f32 v34, v68, v69
    v_cvt_pk_bf16_f32 v35, v70, v71
    v_cvt_pk_bf16_f32 v36, v72, v73
    v_cvt_pk_bf16_f32 v37, v74, v75
    v_cvt_pk_bf16_f32 v38, v76, v77
    v_cvt_pk_bf16_f32 v39, v78, v79
    v_cvt_pk_bf16_f32 v40, v80, v81
    v_cvt_pk_bf16_f32 v41, v82, v83
    v_cvt_pk_bf16_f32 v42, v84, v85
    v_cvt_pk_bf16_f32 v43, v86, v87
    v_cvt_pk_bf16_f32 v44, v88, v89
    v_cvt_pk_bf16_f32 v45, v90, v91
    v_cvt_pk_bf16_f32 v46, v92, v93
    v_cvt_pk_bf16_f32 v47, v94, v95
    s_waitcnt lgkmcnt(0)
    v_mfma_f32_32x32x16_bf16 v[96:111], v[32:35], v[24:27], 0
    v_mfma_f32_32x32x16_bf16 v[48:63], v[40:43], v[24:27], 0
    v_mfma_f32_32x32x16_bf16 v[96:111], v[36:39], v[28:31], v[96:111]
    v_mfma_f32_32x32x16_bf16 v[48:63], v[44:47], v[28:31], v[48:63]
    v_pk_add_f32 v[16:17], v[64:65], v[66:67]
    v_pk_add_f32 v[18:19], v[68:69], v[70:71]
    v_pk_add_f32 v[16:17], v[16:17], v[72:73]
    v_pk_add_f32 v[18:19], v[18:19], v[74:75]
    v_pk_add_f32 v[16:17], v[16:17], v[76:77]
    v_pk_add_f32 v[18:19], v[18:19], v[78:79]
    v_pk_add_f32 v[16:17], v[16:17], v[18:19]
    v_add_f32 v16, v16, v17
    v_mov_b32 v17, v16
    s_nop 1
    v_permlane32_swap_b32 v17, v16
    v_add_f32 v16, v16, v17
    v_pk_add_f32 v[20:21], v[80:81], v[82:83]
    v_pk_add_f32 v[22:23], v[84:85], v[86:87]
    v_pk_add_f32 v[20:21], v[20:21], v[88:89]
    v_pk_add_f32 v[22:23], v[22:23], v[90:91]
    v_pk_add_f32 v[20:21], v[20:21], v[92:93]
    v_pk_add_f32 v[22:23], v[22:23], v[94:95]
    v_pk_add_f32 v[20:21], v[20:21], v[22:23]
    v_add_f32 v20, v20, v21
    v_mov_b32 v21, v20
    s_nop 1
    v_permlane32_swap_b32 v21, v20
    v_add_f32 v20, v20, v21
    ds_write_b32 v14, v16 offset:512
    ds_write_b32 v14, v20 offset:1600
    v_cndmask_b32 v112, v104, v96, vcc
    v_cndmask_b32 v113, v105, v97, vcc
    v_cndmask_b32 v114, v106, v98, vcc
    v_cndmask_b32 v115, v107, v99, vcc
    v_cndmask_b32 v116, v108, v100, vcc
    v_cndmask_b32 v117, v109, v101, vcc
    v_cndmask_b32 v118, v110, v102, vcc
    v_cndmask_b32 v119, v111, v103, vcc
    v_cndmask_b32 v120, v56, v48, vcc
    v_cndmask_b32 v121, v57, v49, vcc
    v_cndmask_b32 v122, v58, v50, vcc
    v_cndmask_b32 v123, v59, v51, vcc
    v_cndmask_b32 v124, v60, v52, vcc
    v_cndmask_b32 v125, v61, v53, vcc
    v_cndmask_b32 v126, v62, v54, vcc
    v_cndmask_b32 v127, v63, v55, vcc
    ds_write_b128 v4, v[112:115] offset:0
    ds_write_b128 v4, v[116:119] offset:16
    ds_write_b128 v4, v[120:123] offset:1088
    ds_write_b128 v4, v[124:127] offset:1104
    v_mov_b32 v9, 17
    ds_write_b32 v8, v9
    s_and_b32 s60, s54, 1
    v_mov_b32 v10, 163376
    s_mov_b32 s59, 0x4000
LW_41:
    ds_read_b32 v9, v10
    s_waitcnt lgkmcnt(0)
    v_cmp_gt_u32 vcc, 3, v9
    s_cbranch_vccz LW_41_D
    s_sub_u32 s59, s59, 1
    s_cmp_lg_u32 s59, 0
    s_cbranch_scc1 LW_41
LW_41_D:
    v_lshlrev_b32 v15, 2, v1
    s_mul_i32 s58, s45, 8704
    s_add_u32 s58, s58, 82944
    s_lshl_b32 s61, s44, 11
    s_add_u32 s58, s58, s61
    v_add_u32 v4, s58, v15
    s_mul_i32 s62, s47, 4352
    s_add_u32 s62, s62, s61
    s_mul_i32 s60, s60, 69632
    s_add_u32 s62, s62, s60
    v_and_b32 v10, 3, v1
    v_lshlrev_b32 v10, 2, v10
    v_add_u32 v10, 163328, v10
    s_mov_b32 s59, 0x4000
LW_42:
    ds_read_b32 v9, v10
    s_waitcnt lgkmcnt(0)
    v_cmp_gt_u32 vcc, 17, v9
    s_cbranch_vccz LW_42_D
    s_sub_u32 s59, s59, 1
    s_cmp_lg_u32 s59, 0
    s_cbranch_scc1 LW_42
LW_42_D:
    ds_read2st64_b32 v[16:17], v4 offset0:0 offset1:1
    ds_read2st64_b32 v[18:19], v4 offset0:2 offset1:3
    ds_read2st64_b32 v[20:21], v4 offset0:4 offset1:5
    ds_read2st64_b32 v[22:23], v4 offset0:6 offset1:7
    ds_read2st64_b32 v[24:25], v4 offset0:17 offset1:18
    ds_read2st64_b32 v[26:27], v4 offset0:19 offset1:20
    ds_read2st64_b32 v[28:29], v4 offset0:21 offset1:22
    ds_read2st64_b32 v[30:31], v4 offset0:23 offset1:24
    ds_read2st64_b32 v[32:33], v4 offset0:16 offset1:33
    v_mov_b32 v9, 18
    ds_write_b32 v8, v9
    s_waitcnt lgkmcnt(2)
    v_pk_add_f32 v[16:17], v[16:17], v[24:25]
    v_pk_add_f32 v[18:19], v[18:19], v[26:27]
    v_pk_add_f32 v[20:21], v[20:21], v[28:29]
    v_pk_add_f32 v[22:23], v[22:23], v[30:31]
    buffer_atomic_add_f32 v16, v15, s[36:39], s62 offen offset:0 sc1
    buffer_atomic_add_f32 v17, v15, s[36:39], s62 offen offset:256 sc1
    buffer_atomic_add_f32 v18, v15, s[36:39], s62 offen offset:512 sc1
    buffer_atomic_add_f32 v19, v15, s[36:39], s62 offen offset:768 sc1
    buffer_atomic_add_f32 v20, v15, s[36:39], s62 offen offset:1024 sc1
    buffer_atomic_add_f32 v21, v15, s[36:39], s62 offen offset:1280 sc1
    buffer_atomic_add_f32 v22, v15, s[36:39], s62 offen offset:1536 sc1
    buffer_atomic_add_f32 v23, v15, s[36:39], s62 offen offset:1792 sc1
    s_cmp_lg_u32 s44, 0
    s_cbranch_scc1 P1_KF
    s_waitcnt lgkmcnt(0)
    v_add_f32 v32, v32, v33
    s_add_u32 s62, s62, 4096
    buffer_atomic_add_f32 v32, v15, s[36:39], s62 offen sc1
P1_KF:
    s_waitcnt vmcnt(0)
    v_mov_b32 v9, 19
    ds_write_b32 v8, v9
    s_setprio 0
    s_mov_b32 s40, s4
    s_mov_b32 s41, s5
    s_mov_b32 s42, 0x200000
    s_mov_b32 s43, 0x00020000
    v_lshlrev_b32 v15, 10, v2
    v_lshl_add_u32 v15, v3, 4, v15
    s_lshl_b32 s46, s54, 16
    s_lshl_b32 s58, s57, 15
    s_add_u32 s46, s46, s58
    s_lshl_b32 s58, s55, 7
    s_add_u32 s46, s46, s58
    s_lshl_b32 s58, s56, 5
    s_add_u32 s46, s46, s58
    buffer_load_dwordx4 v[20:23], v15, s[40:43], s46 offen
    s_branch P2B
P1_QT:
    v_permlane32_swap_b32 v48, v52
    v_permlane32_swap_b32 v49, v53
    v_permlane32_swap_b32 v50, v54
    v_permlane32_swap_b32 v51, v55
    v_permlane32_swap_b32 v56, v60
    v_permlane32_swap_b32 v57, v61
    v_permlane32_swap_b32 v58, v62
    v_permlane32_swap_b32 v59, v63
    s_add_u32 s32, s28, 0x2400000
    s_addc_u32 s33, s29, 0
    s_mov_b32 s34, 0x200000
    s_mov_b32 s35, 0x00020000
    v_min_u32 v11, 16, v2
    v_lshlrev_b32 v11, 5, v11
    v_lshl_add_u32 v11, v3, 4, v11
    s_mul_i32 s62, s47, 4352
    s_lshl_b32 s60, s54, 16
    s_lshl_b32 s61, s44, 15
    s_add_u32 s60, s60, s61
    s_lshl_b32 s61, s47, 11
    s_add_u32 s60, s60, s61
    s_mov_b32 s40, s4
    s_mov_b32 s41, s5
    s_mov_b32 s42, 0x200000
    s_mov_b32 s43, 0x00020000
    v_lshlrev_b32 v15, 10, v2
    v_lshl_add_u32 v15, v3, 4, v15
    s_lshl_b32 s46, s54, 16
    s_lshl_b32 s58, s57, 15
    s_add_u32 s46, s46, s58
    s_lshl_b32 s58, s55, 7
    s_add_u32 s46, s46, s58
    s_lshl_b32 s58, s56, 5
    s_add_u32 s46, s46, s58
    buffer_load_dwordx4 v[4:7], v15, s[40:43], s46 offen
    v_mov_b32 v10, 163376
    s_mov_b32 s59, 0x4000
LW_43:
    ds_read_b32 v9, v10
    s_waitcnt lgkmcnt(0)
    v_cmp_gt_u32 vcc, 5, v9
    s_cbranch_vccz LW_43_D
    s_sub_u32 s59, s59, 1
    s_cmp_lg_u32 s59, 0
    s_cbranch_scc1 LW_43
LW_43_D:
    s_add_u32 s61, s62, 0
    buffer_load_dwordx4 v[64:67], v11, s[36:39], s61 offen offset:0 sc1
    buffer_load_dwordx4 v[68:71], v11, s[36:39], s61 offen offset:544 sc1
    buffer_load_dwordx4 v[72:75], v11, s[36:39], s61 offen offset:1088 sc1
    buffer_load_dwordx4 v[76:79], v11, s[36:39], s61 offen offset:1632 sc1
    s_add_u32 s61, s62, 69632
    buffer_load_dwordx4 v[80:83], v11, s[36:39], s61 offen offset:0 sc1
    buffer_load_dwordx4 v[84:87], v11, s[36:39], s61 offen offset:544 sc1
    buffer_load_dwordx4 v[88:91], v11, s[36:39], s61 offen offset:1088 sc1
    buffer_load_dwordx4 v[92:95], v11, s[36:39], s61 offen offset:1632 sc1
    s_add_u32 s61, s62, 2176
    buffer_load_dwordx4 v[96:99], v11, s[36:39], s61 offen offset:0 sc1
    buffer_load_dwordx4 v[100:103], v11, s[36:39], s61 offen offset:544 sc1
    buffer_load_dwordx4 v[104:107], v11, s[36:39], s61 offen offset:1088 sc1
    buffer_load_dwordx4 v[108:111], v11, s[36:39], s61 offen offset:1632 sc1
    s_add_u32 s61, s62, 71808
    buffer_load_dwordx4 v[112:115], v11, s[36:39], s61 offen offset:0 sc1
    buffer_load_dwordx4 v[116:119], v11, s[36:39], s61 offen offset:544 sc1
    buffer_load_dwordx4 v[120:123], v11, s[36:39], s61 offen offset:1088 sc1
    buffer_load_dwordx4 v[124:127], v11, s[36:39], s61 offen offset:1632 sc1
    v_mov_b32 v9, 17
    ds_write_b32 v8, v9
    s_waitcnt vmcnt(8)
    v_pk_add_f32 v[64:65], v[64:65], v[80:81]
    v_pk_add_f32 v[66:67], v[66:67], v[82:83]
    v_pk_add_f32 v[68:69], v[68:69], v[84:85]
    v_pk_add_f32 v[70:71], v[70:71], v[86:87]
    v_pk_add_f32 v[72:73], v[72:73], v[88:89]
    v_pk_add_f32 v[74:75], v[74:75], v[90:91]
    v_pk_add_f32 v[76:77], v[76:77], v[92:93]
    v_pk_add_f32 v[78:79], v[78:79], v[94:95]
    v_cvt_pk_bf16_f32 v16, v64, v65
    v_cvt_pk_bf16_f32 v17, v66, v67
    v_cvt_pk_bf16_f32 v18, v68, v69
    v_cvt_pk_bf16_f32 v19, v70, v71
    v_cvt_pk_bf16_f32 v20, v72, v73
    v_cvt_pk_bf16_f32 v21, v74, v75
    v_cvt_pk_bf16_f32 v22, v76, v77
    v_cvt_pk_bf16_f32 v23, v78, v79
    v_mfma_f32_32x32x16_bf16 v[32:47], v[16:19], v[48:51], 0
    s_nop 0
    v_mfma_f32_32x32x16_bf16 v[32:47], v[20:23], v[56:59], v[32:47]
    s_waitcnt vmcnt(0)
    v_pk_add_f32 v[96:97], v[96:97], v[112:113]
    v_pk_add_f32 v[98:99], v[98:99], v[114:115]
    v_pk_add_f32 v[100:101], v[100:101], v[116:117]
    v_pk_add_f32 v[102:103], v[102:103], v[118:119]
    v_pk_add_f32 v[104:105], v[104:105], v[120:121]
    v_pk_add_f32 v[106:107], v[106:107], v[122:123]
    v_pk_add_f32 v[108:109], v[108:109], v[124:125]
    v_pk_add_f32 v[110:111], v[110:111], v[126:127]
    v_cvt_pk_bf16_f32 v24, v96, v97
    v_cvt_pk_bf16_f32 v25, v98, v99
    v_cvt_pk_bf16_f32 v26, v100, v101
    v_cvt_pk_bf16_f32 v27, v102, v103
    v_cvt_pk_bf16_f32 v28, v104, v105
    v_cvt_pk_bf16_f32 v29, v106, v107
    v_cvt_pk_bf16_f32 v30, v108, v109
    v_cvt_pk_bf16_f32 v31, v110, v111
    v_mfma_f32_32x32x16_bf16 v[64:79], v[24:27], v[52:55], 0
    s_nop 0
    v_mfma_f32_32x32x16_bf16 v[64:79], v[28:31], v[60:63], v[64:79]
    v_cvt_pk_bf16_f32 v96, v40, v40
    v_lshlrev_b32 v96, 16, v96
    v_add_f32 v96, 0x358637bd, v96
    v_cvt_pk_bf16_f32 v96, v96, v96
    v_lshlrev_b32 v96, 16, v96
    v_rcp_f32 v96, v96
    s_nop 0
    v_mov_b32 v97, v96
    v_pk_mul_f32 v[32:33], v[32:33], v[96:97]
    v_pk_mul_f32 v[34:35], v[34:35], v[96:97]
    v_pk_mul_f32 v[36:37], v[36:37], v[96:97]
    v_pk_mul_f32 v[38:39], v[38:39], v[96:97]
    v_cvt_pk_bf16_f32 v100, v32, v33
    v_cvt_pk_bf16_f32 v101, v34, v35
    v_cvt_pk_bf16_f32 v102, v36, v37
    v_cvt_pk_bf16_f32 v103, v38, v39
    buffer_store_dwordx4 v[100:103], v13, s[32:35], s60 offen offset:0 sc1
    v_cvt_pk_bf16_f32 v98, v72, v72
    v_lshlrev_b32 v98, 16, v98
    v_add_f32 v98, 0x358637bd, v98
    v_cvt_pk_bf16_f32 v98, v98, v98
    v_lshlrev_b32 v98, 16, v98
    v_rcp_f32 v98, v98
    s_nop 0
    v_mov_b32 v99, v98
    v_pk_mul_f32 v[64:65], v[64:65], v[98:99]
    v_pk_mul_f32 v[66:67], v[66:67], v[98:99]
    v_pk_mul_f32 v[68:69], v[68:69], v[98:99]
    v_pk_mul_f32 v[70:71], v[70:71], v[98:99]
    v_cvt_pk_bf16_f32 v104, v64, v65
    v_cvt_pk_bf16_f32 v105, v66, v67
    v_cvt_pk_bf16_f32 v106, v68, v69
    v_cvt_pk_bf16_f32 v107, v70, v71
    buffer_store_dwordx4 v[104:107], v13, s[32:35], s60 offen offset:1024 sc1
    v_mov_b32 v20, v4
    v_mov_b32 v21, v5
    v_mov_b32 v22, v6
    v_mov_b32 v23, v7
    s_waitcnt vmcnt(0)
    v_mov_b32 v9, 19
    ds_write_b32 v8, v9
P2B:
    s_add_u32 s32, s28, 0x2400000
    s_addc_u32 s33, s29, 0
    s_mov_b32 s34, 0x200000
    s_mov_b32 s35, 0x00020000
    s_lshl_b32 s45, s54, 16
    s_lshl_b32 s58, s57, 15
    s_add_u32 s45, s45, s58
    v_bfe_u32 v5, v1, 2, 2
    v_lshl_add_u32 v5, v3, 2, v5
    v_lshlrev_b32 v5, 7, v5
    v_bfe_u32 v6, v1, 4, 1
    v_add_u32 v6, s56, v6
    v_bfe_u32 v12, v1, 3, 1
    v_lshlrev_b32 v12, 1, v12
    v_xor_b32 v6, v6, v12
    v_and_b32 v6, 3, v6
    v_lshl_add_u32 v5, v6, 5, v5
    v_and_b32 v6, 3, v1
    v_lshl_add_u32 v12, v6, 3, v5
    s_lshl_b32 s58, s56, 14
    s_add_u32 s58, s58, 91136
    v_add_u32 v16, s58, v12
    v_xor_b32 v17, 64, v12
    v_add_u32 v17, s58, v17
    s_lshl_b32 s59, s57, 13
    s_add_u32 s58, s58, s59
    v_add_u32 v24, s58, v13
    s_sub_u32 s58, s56, 1
    s_and_b32 s58, s58, 3
    s_lshl_b32 s58, s58, 14
    s_add_u32 s58, s58, s59
    s_add_u32 s58, s58, 91136
    v_add_u32 v25, s58, v13
    s_sub_u32 s58, s56, 2
    s_and_b32 s58, s58, 3
    s_lshl_b32 s58, s58, 14
    s_add_u32 s58, s58, s59
    s_add_u32 s58, s58, 91136
    v_add_u32 v26, s58, v13
    s_sub_u32 s58, s56, 3
    s_and_b32 s58, s58, 3
    s_lshl_b32 s58, s58, 14
    s_add_u32 s58, s58, s59
    s_add_u32 s58, s58, 91136
    v_add_u32 v27, s58, v13
    s_lshl_b32 s58, s56, 13
    s_add_u32 s44, s45, s58
    v_lshlrev_b32 v14, 4, v3
    s_lshl_b32 s58, s56, 6
    s_add_u32 s58, s58, 162560
    v_add_u32 v14, s58, v14
    v_and_b32 v10, 3, v1
    v_lshlrev_b32 v10, 2, v10
    v_add_u32 v10, 163360, v10
    s_mov_b32 s59, 0x4000
LW_44:
    ds_read_b32 v9, v10
    s_waitcnt lgkmcnt(0)
    v_cmp_gt_u32 vcc, 26, v9
    s_cbranch_vccz LW_44_D
    s_sub_u32 s59, s59, 1
    s_cmp_lg_u32 s59, 0
    s_cbranch_scc1 LW_44
LW_44_D:
    ds_read_b64_tr_b16 v[32:33], v16 offset:0
    ds_read_b64_tr_b16 v[34:35], v16 offset:1024
    ds_read_b64_tr_b16 v[36:37], v17 offset:0
    ds_read_b64_tr_b16 v[38:39], v17 offset:1024
    ds_read_b64_tr_b16 v[40:41], v16 offset:2048
    ds_read_b64_tr_b16 v[42:43], v16 offset:3072
    ds_read_b64_tr_b16 v[44:45], v17 offset:2048
    ds_read_b64_tr_b16 v[46:47], v17 offset:3072
    ds_read_b64_tr_b16 v[48:49], v16 offset:4096
    ds_read_b64_tr_b16 v[50:51], v16 offset:5120
    ds_read_b64_tr_b16 v[52:53], v17 offset:4096
    ds_read_b64_tr_b16 v[54:55], v17 offset:5120
    v_mov_b32 v10, 163376
    s_mov_b32 s59, 0x4000
LW_45:
    ds_read_b32 v9, v10
    s_waitcnt lgkmcnt(0)
    v_cmp_gt_u32 vcc, 7, v9
    s_cbranch_vccz LW_45_D
    s_sub_u32 s59, s59, 1
    s_cmp_lg_u32 s59, 0
    s_cbranch_scc1 LW_45
LW_45_D:
    buffer_load_dwordx4 v[64:67], v13, s[32:35], s44 offen offset:0 sc1
    buffer_load_dwordx4 v[68:71], v13, s[32:35], s44 offen offset:1024 sc1
    buffer_load_dwordx4 v[72:75], v13, s[32:35], s44 offen offset:2048 sc1
    buffer_load_dwordx4 v[76:79], v13, s[32:35], s44 offen offset:3072 sc1
    s_add_u32 s44, s44, 4096
    buffer_load_dwordx4 v[80:83], v13, s[32:35], s44 offen offset:0 sc1
    buffer_load_dwordx4 v[84:87], v13, s[32:35], s44 offen offset:1024 sc1
    buffer_load_dwordx4 v[88:91], v13, s[32:35], s44 offen offset:2048 sc1
    buffer_load_dwordx4 v[92:95], v13, s[32:35], s44 offen offset:3072 sc1
    s_waitcnt vmcnt(7) lgkmcnt(8)
    v_mfma_f32_32x32x16_bf16 v[96:111], v[32:35], v[64:67], 0
    v_mfma_f32_32x32x16_bf16 v[112:127], v[36:39], v[64:67], 0
    ds_read_b64_tr_b16 v[56:57], v16 offset:6144
    ds_read_b64_tr_b16 v[58:59], v16 offset:7168
    ds_read_b64_tr_b16 v[60:61], v17 offset:6144
    ds_read_b64_tr_b16 v[62:63], v17 offset:7168
    s_waitcnt vmcnt(6) lgkmcnt(8)
    v_mfma_f32_32x32x16_bf16 v[96:111], v[40:43], v[68:71], v[96:111]
    v_mfma_f32_32x32x16_bf16 v[112:127], v[44:47], v[68:71], v[112:127]
    ds_read_b64_tr_b16 v[32:33], v16 offset:8192
    ds_read_b64_tr_b16 v[34:35], v16 offset:9216
    ds_read_b64_tr_b16 v[36:37], v17 offset:8192
    ds_read_b64_tr_b16 v[38:39], v17 offset:9216
    s_waitcnt vmcnt(5) lgkmcnt(8)
    v_mfma_f32_32x32x16_bf16 v[96:111], v[48:51], v[72:75], v[96:111]
    v_mfma_f32_32x32x16_bf16 v[112:127], v[52:55], v[72:75], v[112:127]
    ds_read_b64_tr_b16 v[40:41], v16 offset:10240
    ds_read_b64_tr_b16 v[42:43], v16 offset:11264
    ds_read_b64_tr_b16 v[44:45], v17 offset:10240
    ds_read_b64_tr_b16 v[46:47], v17 offset:11264
    s_waitcnt vmcnt(4) lgkmcnt(8)
    v_mfma_f32_32x32x16_bf16 v[96:111], v[56:59], v[76:79], v[96:111]
    v_mfma_f32_32x32x16_bf16 v[112:127], v[60:63], v[76:79], v[112:127]
    ds_read_b64_tr_b16 v[48:49], v16 offset:12288
    ds_read_b64_tr_b16 v[50:51], v16 offset:13312
    ds_read_b64_tr_b16 v[52:53], v17 offset:12288
    ds_read_b64_tr_b16 v[54:55], v17 offset:13312
    s_waitcnt vmcnt(3) lgkmcnt(8)
    v_mfma_f32_32x32x16_bf16 v[96:111], v[32:35], v[80:83], v[96:111]
    v_mfma_f32_32x32x16_bf16 v[112:127], v[36:39], v[80:83], v[112:127]
    ds_read_b64_tr_b16 v[56:57], v16 offset:14336
    ds_read_b64_tr_b16 v[58:59], v16 offset:15360
    ds_read_b64_tr_b16 v[60:61], v17 offset:14336
    ds_read_b64_tr_b16 v[62:63], v17 offset:15360
    v_mov_b32 v9, 20
    ds_write_b32 v8, v9
    s_waitcnt vmcnt(2) lgkmcnt(9)
    v_mfma_f32_32x32x16_bf16 v[96:111], v[40:43], v[84:87], v[96:111]
    v_mfma_f32_32x32x16_bf16 v[112:127], v[44:47], v[84:87], v[112:127]
    s_waitcnt vmcnt(1) lgkmcnt(5)
    v_mfma_f32_32x32x16_bf16 v[96:111], v[48:51], v[88:91], v[96:111]
    v_mfma_f32_32x32x16_bf16 v[112:127], v[52:55], v[88:91], v[112:127]
    s_waitcnt vmcnt(0) lgkmcnt(1)
    v_mfma_f32_32x32x16_bf16 v[96:111], v[56:59], v[92:95], v[96:111]
    v_mfma_f32_32x32x16_bf16 v[112:127], v[60:63], v[92:95], v[112:127]
    v_mov_b32 v10, 163376
    s_mov_b32 s59, 0x4000
LW_46:
    ds_read_b32 v9, v10
    s_waitcnt lgkmcnt(0)
    v_cmp_gt_u32 vcc, 8, v9
    s_cbranch_vccz LW_46_D
    s_sub_u32 s59, s59, 1
    s_cmp_lg_u32 s59, 0
    s_cbranch_scc1 LW_46
LW_46_D:
    ds_read_b128 v[32:35], v14 offset:0
    ds_read_b128 v[40:43], v14 offset:256
    ds_read_b128 v[36:39], v14 offset:32
    ds_read_b128 v[44:47], v14 offset:288
    s_xor_b32 s58, s3, 4
    s_lshl_b32 s58, s58, 2
    s_add_u32 s58, s58, 163328
    v_mov_b32 v10, s58
    s_mov_b32 s59, 0x4000
LW_47:
    ds_read_b32 v9, v10
    s_waitcnt lgkmcnt(0)
    v_cmp_gt_u32 vcc, 20, v9
    s_cbranch_vccz LW_47_D
    s_sub_u32 s59, s59, 1
    s_cmp_lg_u32 s59, 0
    s_cbranch_scc1 LW_47
LW_47_D:
    s_nop 7
    ds_write_b128 v24, v[104:107] offset:0
    ds_write_b128 v24, v[108:111] offset:1024
    ds_write_b128 v24, v[112:115] offset:2048
    ds_write_b128 v24, v[116:119] offset:3072
    ds_write_b128 v24, v[120:123] offset:4096
    ds_write_b128 v24, v[124:127] offset:5120
    v_mov_b32 v9, 21
    ds_write_b32 v8, v9
    v_and_b32 v10, 3, v1
    v_lshlrev_b32 v10, 2, v10
    v_add_u32 v10, 163328, v10
    s_lshl_b32 s59, s57, 4
    v_add_u32 v10, s59, v10
    s_mov_b32 s59, 0x4000
LW_48:
    ds_read_b32 v9, v10
    s_waitcnt lgkmcnt(0)
    v_cmp_gt_u32 vcc, 21, v9
    s_cbranch_vccz LW_48_D
    s_sub_u32 s59, s59, 1
    s_cmp_lg_u32 s59, 0
    s_cbranch_scc1 LW_48
LW_48_D:
    ds_read_b128 v[64:67], v25 offset:0
    ds_read_b128 v[68:71], v25 offset:1024
    ds_read_b128 v[72:75], v26 offset:2048
    ds_read_b128 v[76:79], v26 offset:3072
    ds_read_b128 v[80:83], v27 offset:4096
    ds_read_b128 v[84:87], v27 offset:5120
    s_waitcnt lgkmcnt(2)
    v_pk_add_f32 v[64:65], v[64:65], v[72:73]
    v_pk_add_f32 v[66:67], v[66:67], v[74:75]
    v_pk_add_f32 v[68:69], v[68:69], v[76:77]
    v_pk_add_f32 v[70:71], v[70:71], v[78:79]
    s_waitcnt lgkmcnt(0)
    v_pk_add_f32 v[96:97], v[96:97], v[80:81]
    v_pk_add_f32 v[98:99], v[98:99], v[82:83]
    v_pk_add_f32 v[100:101], v[100:101], v[84:85]
    v_pk_add_f32 v[102:103], v[102:103], v[86:87]
    v_pk_add_f32 v[96:97], v[96:97], v[64:65]
    v_pk_add_f32 v[98:99], v[98:99], v[66:67]
    v_pk_add_f32 v[100:101], v[100:101], v[68:69]
    v_pk_add_f32 v[102:103], v[102:103], v[70:71]
    v_mov_b32 v9, 22
    ds_write_b32 v8, v9
    v_permlane32_swap_b32 v20, v22
    v_permlane32_swap_b32 v21, v23
    v_cvt_pk_bf16_f32 v4, v96, v97
    v_cvt_pk_bf16_f32 v5, v98, v99
    v_cvt_pk_bf16_f32 v6, v100, v101
    v_cvt_pk_bf16_f32 v7, v102, v103
    v_lshlrev_b32 v96, 16, v4
    v_and_b32 v97, 0xffff0000, v4
    v_lshlrev_b32 v98, 16, v5
    v_and_b32 v99, 0xffff0000, v5
    v_lshlrev_b32 v100, 16, v6
    v_and_b32 v101, 0xffff0000, v6
    v_lshlrev_b32 v102, 16, v7
    v_and_b32 v103, 0xffff0000, v7
    v_pk_mul_f32 v[96:97], v[96:97], v[32:33]
    v_pk_mul_f32 v[98:99], v[98:99], v[34:35]
    v_pk_mul_f32 v[100:101], v[100:101], v[36:37]
    v_pk_mul_f32 v[102:103], v[102:103], v[38:39]
    v_lshlrev_b32 v64, 16, v20
    v_and_b32 v65, 0xffff0000, v20
    v_lshlrev_b32 v66, 16, v21
    v_and_b32 v67, 0xffff0000, v21
    v_lshlrev_b32 v68, 16, v22
    v_and_b32 v69, 0xffff0000, v22
    v_lshlrev_b32 v70, 16, v23
    v_and_b32 v71, 0xffff0000, v23
    v_cvt_pk_bf16_f32 v4, v96, v97
    v_cvt_pk_bf16_f32 v5, v98, v99
    v_cvt_pk_bf16_f32 v6, v100, v101
    v_cvt_pk_bf16_f32 v7, v102, v103
    v_lshlrev_b32 v96, 16, v4
    v_and_b32 v97, 0xffff0000, v4
    v_lshlrev_b32 v98, 16, v5
    v_and_b32 v99, 0xffff0000, v5
    v_lshlrev_b32 v100, 16, v6
    v_and_b32 v101, 0xffff0000, v6
    v_lshlrev_b32 v102, 16, v7
    v_and_b32 v103, 0xffff0000, v7
    v_pk_add_f32 v[96:97], v[96:97], v[64:65]
    v_pk_add_f32 v[98:99], v[98:99], v[66:67]
    v_pk_add_f32 v[100:101], v[100:101], v[68:69]
    v_pk_add_f32 v[102:103], v[102:103], v[70:71]
    v_cvt_pk_bf16_f32 v4, v96, v97
    v_cvt_pk_bf16_f32 v5, v98, v99
    v_cvt_pk_bf16_f32 v6, v100, v101
    v_cvt_pk_bf16_f32 v7, v102, v103
    s_add_u32 s32, s28, 0x2000000
    s_addc_u32 s33, s29, 0
    s_mov_b32 s34, 0x200000
    s_mov_b32 s35, 0x00020000
    v_lshlrev_b32 v96, 16, v4
    v_and_b32 v97, 0xffff0000, v4
    v_lshlrev_b32 v98, 16, v5
    v_and_b32 v99, 0xffff0000, v5
    v_lshlrev_b32 v100, 16, v6
    v_and_b32 v101, 0xffff0000, v6
    v_lshlrev_b32 v102, 16, v7
    v_and_b32 v103, 0xffff0000, v7
    v_pk_mul_f32 v[64:65], v[96:97], v[40:41]
    v_pk_mul_f32 v[66:67], v[98:99], v[42:43]
    v_pk_mul_f32 v[68:69], v[100:101], v[44:45]
    v_pk_mul_f32 v[70:71], v[102:103], v[46:47]
    v_cvt_pk_bf16_f32 v72, v64, v65
    v_cvt_pk_bf16_f32 v73, v66, v67
    v_cvt_pk_bf16_f32 v74, v68, v69
    v_cvt_pk_bf16_f32 v75, v70, v71
    s_lshl_b32 s60, s55, 2
    s_add_u32 s60, s60, s56
    s_lshl_b32 s44, s60, 10
    s_add_u32 s44, s44, s45
    buffer_store_dwordx4 v[72:75], v13, s[32:35], s44 offen sc1
    v_pk_add_f32 v[80:81], v[96:97], v[98:99]
    v_pk_mul_f32 v[84:85], v[96:97], v[96:97]
    v_pk_add_f32 v[82:83], v[100:101], v[102:103]
    v_pk_mul_f32 v[86:87], v[98:99], v[98:99]
    v_pk_add_f32 v[80:81], v[80:81], v[82:83]
    v_pk_fma_f32 v[84:85], v[100:101], v[100:101], v[84:85]
    v_pk_fma_f32 v[86:87], v[102:103], v[102:103], v[86:87]
    v_pk_add_f32 v[84:85], v[84:85], v[86:87]
    v_add_f32 v76, v80, v81
    v_add_f32 v77, v84, v85
    v_mov_b32 v78, v76
    v_mov_b32 v79, v77
    s_nop 0
    v_permlane32_swap_b32 v78, v76
    v_permlane32_swap_b32 v79, v77
    v_pk_add_f32 v[76:77], v[76:77], v[78:79]
    v_lshlrev_b32 v84, 3, v2
    s_lshl_b32 s58, s3, 8
    s_add_u32 s58, s58, 160512
    v_add_u32 v84, s58, v84
    ds_write_b64 v84, v[76:77]
    v_mov_b32 v9, 23
    ds_write_b32 v8, v9
    v_bfe_u32 v19, v1, 4, 1
    v_bfe_u32 v16, v1, 2, 2
    v_lshl_add_u32 v16, v3, 2, v16
    v_mul_u32_u24 v16, 96, v16
    v_mul_u32_u24 v19, 6272, v19
    v_add_u32 v16, v16, v19
    v_and_b32 v19, 3, v1
    v_lshl_add_u32 v16, v19, 3, v16
    v_add_u32 v17, 32, v16
    v_add_u32 v18, 64, v16
    s_and_b32 s43, s2, 7
    s_lshl_b32 s43, s43, 3
    s_add_u32 s43, s43, s3
    s_lshl_b32 s44, s43, 15
    v_and_b32 v19, 3, v1
    v_lshlrev_b32 v19, 2, v19
    v_add_u32 v19, 163360, v19
    s_waitcnt vmcnt(0)
    v_mov_b32 v9, 24
    ds_write_b32 v8, v9
    s_lshr_b32 s58, s2, 3
    s_lshr_b32 s59, s2, 5
    s_lshl_b32 s59, 1, s59
    s_and_b32 s59, s59, 136
    s_cselect_b32 s59, 16, 0
    s_xor_b32 s58, s58, s59
    s_cmp_ge_u32 s58, 29
    s_cbranch_scc1 P3_SKIP
    s_setprio 1
    s_cmp_eq_u32 s57, 0
    s_cbranch_scc0 P3_LO
    s_setprio 2
P3_LO:
    s_mov_b32 s59, 0x4000
LW_49:
    ds_read_b32 v9, v19
    s_waitcnt lgkmcnt(0)
    v_cmp_gt_u32 vcc, 33, v9
    s_cbranch_vccz LW_49_D
    s_sub_u32 s59, s59, 1
    s_cmp_lg_u32 s59, 0
    s_cbranch_scc1 LW_49
LW_49_D:
    ds_read_b64_tr_b16 v[44:45], v16 offset:0
    ds_read_b64_tr_b16 v[46:47], v16 offset:768
    ds_read_b64_tr_b16 v[48:49], v17 offset:0
    ds_read_b64_tr_b16 v[50:51], v17 offset:768
    ds_read_b64_tr_b16 v[52:53], v18 offset:0
    ds_read_b64_tr_b16 v[54:55], v18 offset:768
    ds_read_b64_tr_b16 v[56:57], v16 offset:1536
    ds_read_b64_tr_b16 v[58:59], v16 offset:2304
    ds_read_b64_tr_b16 v[60:61], v17 offset:1536
    ds_read_b64_tr_b16 v[62:63], v17 offset:2304
    ds_read_b64_tr_b16 v[64:65], v18 offset:1536
    ds_read_b64_tr_b16 v[66:67], v18 offset:2304
    v_mov_b32 v10, 163376
    s_mov_b32 s59, 0x4000
LW_50:
    ds_read_b32 v9, v10
    s_waitcnt lgkmcnt(0)
    v_cmp_gt_u32 vcc, 11, v9
    s_cbranch_vccz LW_50_D
    s_sub_u32 s59, s59, 1
    s_cmp_lg_u32 s59, 0
    s_cbranch_scc1 LW_50
LW_50_D:
    s_cmp_eq_u32 s57, 0
    s_cbranch_scc1 P3_GO
    v_and_b32 v10, 3, v1
    v_lshlrev_b32 v10, 2, v10
    v_add_u32 v10, 163328, v10
    s_mov_b32 s59, 0x4000
LW_51:
    ds_read_b32 v9, v10
    s_waitcnt lgkmcnt(0)
    v_cmp_gt_u32 vcc, 28, v9
    s_cbranch_vccz LW_51_D
    s_sub_u32 s59, s59, 1
    s_cmp_lg_u32 s59, 0
    s_cbranch_scc1 LW_51
LW_51_D:
P3_GO:
    buffer_load_dwordx4 v[20:23], v13, s[32:35], s44 offen offset:0 sc1
    buffer_load_dwordx4 v[24:27], v13, s[32:35], s44 offen offset:1024 sc1
    buffer_load_dwordx4 v[28:31], v13, s[32:35], s44 offen offset:2048 sc1
    buffer_load_dwordx4 v[32:35], v13, s[32:35], s44 offen offset:3072 sc1
    s_add_u32 s44, s44, 4096
    buffer_load_dwordx4 v[36:39], v13, s[32:35], s44 offen offset:0 sc1
    buffer_load_dwordx4 v[40:43], v13, s[32:35], s44 offen offset:1024 sc1
    s_waitcnt vmcnt(5) lgkmcnt(6)
    v_mfma_f32_32x32x16_bf16 v[80:95], v[44:47], v[20:23], 0
    ds_read_b64_tr_b16 v[68:69], v16 offset:3072
    ds_read_b64_tr_b16 v[70:71], v16 offset:3840
    v_mfma_f32_32x32x16_bf16 v[96:111], v[48:51], v[20:23], 0
    ds_read_b64_tr_b16 v[72:73], v17 offset:3072
    ds_read_b64_tr_b16 v[74:75], v17 offset:3840
    v_mfma_f32_32x32x16_bf16 v[112:127], v[52:55], v[20:23], 0
    ds_read_b64_tr_b16 v[76:77], v18 offset:3072
    ds_read_b64_tr_b16 v[78:79], v18 offset:3840
    buffer_load_dwordx4 v[20:23], v13, s[32:35], s44 offen offset:2048 sc1
    s_waitcnt vmcnt(5) lgkmcnt(6)
    v_mfma_f32_32x32x16_bf16 v[80:95], v[56:59], v[24:27], v[80:95]
    ds_read_b64_tr_b16 v[44:45], v16 offset:4608
    ds_read_b64_tr_b16 v[46:47], v16 offset:5376
    v_mfma_f32_32x32x16_bf16 v[96:111], v[60:63], v[24:27], v[96:111]
    ds_read_b64_tr_b16 v[48:49], v17 offset:4608
    ds_read_b64_tr_b16 v[50:51], v17 offset:5376
    v_mfma_f32_32x32x16_bf16 v[112:127], v[64:67], v[24:27], v[112:127]
    ds_read_b64_tr_b16 v[52:53], v18 offset:4608
    ds_read_b64_tr_b16 v[54:55], v18 offset:5376
    buffer_load_dwordx4 v[24:27], v13, s[32:35], s44 offen offset:3072 sc1
    v_mov_b32 v9, 25
    ds_write_b32 v8, v9
    s_waitcnt vmcnt(5) lgkmcnt(7)
    v_mfma_f32_32x32x16_bf16 v[80:95], v[68:71], v[28:31], v[80:95]
    ds_read_b64_tr_b16 v[56:57], v16 offset:12544
    ds_read_b64_tr_b16 v[58:59], v16 offset:13312
    v_mfma_f32_32x32x16_bf16 v[96:111], v[72:75], v[28:31], v[96:111]
    ds_read_b64_tr_b16 v[60:61], v17 offset:12544
    ds_read_b64_tr_b16 v[62:63], v17 offset:13312
    v_mfma_f32_32x32x16_bf16 v[112:127], v[76:79], v[28:31], v[112:127]
    ds_read_b64_tr_b16 v[64:65], v18 offset:12544
    ds_read_b64_tr_b16 v[66:67], v18 offset:13312
    s_add_u32 s44, s44, 4096
    buffer_load_dwordx4 v[28:31], v13, s[32:35], s44 offen offset:0 sc1
    s_waitcnt vmcnt(5) lgkmcnt(7)
    v_mfma_f32_32x32x16_bf16 v[80:95], v[44:47], v[32:35], v[80:95]
    ds_read_b64_tr_b16 v[68:69], v16 offset:14080
    ds_read_b64_tr_b16 v[70:71], v16 offset:14848
    v_mfma_f32_32x32x16_bf16 v[96:111], v[48:51], v[32:35], v[96:111]
    ds_read_b64_tr_b16 v[72:73], v17 offset:14080
    ds_read_b64_tr_b16 v[74:75], v17 offset:14848
    v_mfma_f32_32x32x16_bf16 v[112:127], v[52:55], v[32:35], v[112:127]
    ds_read_b64_tr_b16 v[76:77], v18 offset:14080
    ds_read_b64_tr_b16 v[78:79], v18 offset:14848
    buffer_load_dwordx4 v[32:35], v13, s[32:35], s44 offen offset:1024 sc1
    s_waitcnt vmcnt(5) lgkmcnt(6)
    v_mfma_f32_32x32x16_bf16 v[80:95], v[56:59], v[36:39], v[80:95]
    ds_read_b64_tr_b16 v[44:45], v16 offset:15616
    ds_read_b64_tr_b16 v[46:47], v16 offset:16384
    v_mfma_f32_32x32x16_bf16 v[96:111], v[60:63], v[36:39], v[96:111]
    ds_read_b64_tr_b16 v[48:49], v17 offset:15616
    ds_read_b64_tr_b16 v[50:51], v17 offset:16384
    v_mfma_f32_32x32x16_bf16 v[112:127], v[64:67], v[36:39], v[112:127]
    ds_read_b64_tr_b16 v[52:53], v18 offset:15616
    ds_read_b64_tr_b16 v[54:55], v18 offset:16384
    buffer_load_dwordx4 v[36:39], v13, s[32:35], s44 offen offset:2048 sc1
    s_waitcnt vmcnt(5) lgkmcnt(6)
    v_mfma_f32_32x32x16_bf16 v[80:95], v[68:71], v[40:43], v[80:95]
    ds_read_b64_tr_b16 v[56:57], v16 offset:17152
    ds_read_b64_tr_b16 v[58:59], v16 offset:17920
    v_mfma_f32_32x32x16_bf16 v[96:111], v[72:75], v[40:43], v[96:111]
    ds_read_b64_tr_b16 v[60:61], v17 offset:17152
    ds_read_b64_tr_b16 v[62:63], v17 offset:17920
    v_mfma_f32_32x32x16_bf16 v[112:127], v[76:79], v[40:43], v[112:127]
    ds_read_b64_tr_b16 v[64:65], v18 offset:17152
    ds_read_b64_tr_b16 v[66:67], v18 offset:17920
    buffer_load_dwordx4 v[40:43], v13, s[32:35], s44 offen offset:3072 sc1
    v_mov_b32 v9, 26
    ds_write_b32 v8, v9
    s_waitcnt vmcnt(5) lgkmcnt(7)
    v_mfma_f32_32x32x16_bf16 v[80:95], v[44:47], v[20:23], v[80:95]
    ds_read_b64_tr_b16 v[68:69], v16 offset:25088
    ds_read_b64_tr_b16 v[70:71], v16 offset:25856
    v_mfma_f32_32x32x16_bf16 v[96:111], v[48:51], v[20:23], v[96:111]
    ds_read_b64_tr_b16 v[72:73], v17 offset:25088
    ds_read_b64_tr_b16 v[74:75], v17 offset:25856
    v_mfma_f32_32x32x16_bf16 v[112:127], v[52:55], v[20:23], v[112:127]
    ds_read_b64_tr_b16 v[76:77], v18 offset:25088
    ds_read_b64_tr_b16 v[78:79], v18 offset:25856
    s_add_u32 s44, s44, 4096
    buffer_load_dwordx4 v[20:23], v13, s[32:35], s44 offen offset:0 sc1
    s_waitcnt vmcnt(5) lgkmcnt(7)
    v_mfma_f32_32x32x16_bf16 v[80:95], v[56:59], v[24:27], v[80:95]
    ds_read_b64_tr_b16 v[44:45], v16 offset:26624
    ds_read_b64_tr_b16 v[46:47], v16 offset:27392
    v_mfma_f32_32x32x16_bf16 v[96:111], v[60:63], v[24:27], v[96:111]
    ds_read_b64_tr_b16 v[48:49], v17 offset:26624
    ds_read_b64_tr_b16 v[50:51], v17 offset:27392
    v_mfma_f32_32x32x16_bf16 v[112:127], v[64:67], v[24:27], v[112:127]
    ds_read_b64_tr_b16 v[52:53], v18 offset:26624
    ds_read_b64_tr_b16 v[54:55], v18 offset:27392
    buffer_load_dwordx4 v[24:27], v13, s[32:35], s44 offen offset:1024 sc1
    s_waitcnt vmcnt(5) lgkmcnt(6)
    v_mfma_f32_32x32x16_bf16 v[80:95], v[68:71], v[28:31], v[80:95]
    ds_read_b64_tr_b16 v[56:57], v16 offset:28160
    ds_read_b64_tr_b16 v[58:59], v16 offset:28928
    v_mfma_f32_32x32x16_bf16 v[96:111], v[72:75], v[28:31], v[96:111]
    ds_read_b64_tr_b16 v[60:61], v17 offset:28160
    ds_read_b64_tr_b16 v[62:63], v17 offset:28928
    v_mfma_f32_32x32x16_bf16 v[112:127], v[76:79], v[28:31], v[112:127]
    ds_read_b64_tr_b16 v[64:65], v18 offset:28160
    ds_read_b64_tr_b16 v[66:67], v18 offset:28928
    buffer_load_dwordx4 v[28:31], v13, s[32:35], s44 offen offset:2048 sc1
    s_waitcnt vmcnt(5) lgkmcnt(6)
    v_mfma_f32_32x32x16_bf16 v[80:95], v[44:47], v[32:35], v[80:95]
    ds_read_b64_tr_b16 v[68:69], v16 offset:29696
    ds_read_b64_tr_b16 v[70:71], v16 offset:30464
    v_mfma_f32_32x32x16_bf16 v[96:111], v[48:51], v[32:35], v[96:111]
    ds_read_b64_tr_b16 v[72:73], v17 offset:29696
    ds_read_b64_tr_b16 v[74:75], v17 offset:30464
    v_mfma_f32_32x32x16_bf16 v[112:127], v[52:55], v[32:35], v[112:127]
    ds_read_b64_tr_b16 v[76:77], v18 offset:29696
    ds_read_b64_tr_b16 v[78:79], v18 offset:30464
    buffer_load_dwordx4 v[32:35], v13, s[32:35], s44 offen offset:3072 sc1
    v_mov_b32 v9, 27
    ds_write_b32 v8, v9
    s_waitcnt vmcnt(5) lgkmcnt(7)
    v_mfma_f32_32x32x16_bf16 v[80:95], v[56:59], v[36:39], v[80:95]
    ds_read_b64_tr_b16 v[44:45], v16 offset:37632
    ds_read_b64_tr_b16 v[46:47], v16 offset:38400
    v_mfma_f32_32x32x16_bf16 v[96:111], v[60:63], v[36:39], v[96:111]
    ds_read_b64_tr_b16 v[48:49], v17 offset:37632
    ds_read_b64_tr_b16 v[50:51], v17 offset:38400
    v_mfma_f32_32x32x16_bf16 v[112:127], v[64:67], v[36:39], v[112:127]
    ds_read_b64_tr_b16 v[52:53], v18 offset:37632
    ds_read_b64_tr_b16 v[54:55], v18 offset:38400
    s_add_u32 s44, s44, 4096
    buffer_load_dwordx4 v[36:39], v13, s[32:35], s44 offen offset:0 sc1
    s_waitcnt vmcnt(5) lgkmcnt(7)
    v_mfma_f32_32x32x16_bf16 v[80:95], v[68:71], v[40:43], v[80:95]
    ds_read_b64_tr_b16 v[56:57], v16 offset:39168
    ds_read_b64_tr_b16 v[58:59], v16 offset:39936
    v_mfma_f32_32x32x16_bf16 v[96:111], v[72:75], v[40:43], v[96:111]
    ds_read_b64_tr_b16 v[60:61], v17 offset:39168
    ds_read_b64_tr_b16 v[62:63], v17 offset:39936
    v_mfma_f32_32x32x16_bf16 v[112:127], v[76:79], v[40:43], v[112:127]
    ds_read_b64_tr_b16 v[64:65], v18 offset:39168
    ds_read_b64_tr_b16 v[66:67], v18 offset:39936
    buffer_load_dwordx4 v[40:43], v13, s[32:35], s44 offen offset:1024 sc1
    s_waitcnt vmcnt(5) lgkmcnt(6)
    v_mfma_f32_32x32x16_bf16 v[80:95], v[44:47], v[20:23], v[80:95]
    ds_read_b64_tr_b16 v[68:69], v16 offset:40704
    ds_read_b64_tr_b16 v[70:71], v16 offset:41472
    v_mfma_f32_32x32x16_bf16 v[96:111], v[48:51], v[20:23], v[96:111]
    ds_read_b64_tr_b16 v[72:73], v17 offset:40704
    ds_read_b64_tr_b16 v[74:75], v17 offset:41472
    v_mfma_f32_32x32x16_bf16 v[112:127], v[52:55], v[20:23], v[112:127]
    ds_read_b64_tr_b16 v[76:77], v18 offset:40704
    ds_read_b64_tr_b16 v[78:79], v18 offset:41472
    buffer_load_dwordx4 v[20:23], v13, s[32:35], s44 offen offset:2048 sc1
    s_waitcnt vmcnt(5) lgkmcnt(6)
    v_mfma_f32_32x32x16_bf16 v[80:95], v[56:59], v[24:27], v[80:95]
    ds_read_b64_tr_b16 v[44:45], v16 offset:42240
    ds_read_b64_tr_b16 v[46:47], v16 offset:43008
    v_mfma_f32_32x32x16_bf16 v[96:111], v[60:63], v[24:27], v[96:111]
    ds_read_b64_tr_b16 v[48:49], v17 offset:42240
    ds_read_b64_tr_b16 v[50:51], v17 offset:43008
    v_mfma_f32_32x32x16_bf16 v[112:127], v[64:67], v[24:27], v[112:127]
    ds_read_b64_tr_b16 v[52:53], v18 offset:42240
    ds_read_b64_tr_b16 v[54:55], v18 offset:43008
    buffer_load_dwordx4 v[24:27], v13, s[32:35], s44 offen offset:3072 sc1
    v_mov_b32 v9, 28
    ds_write_b32 v8, v9
    v_add_u32 v16, 50176, v16
    v_add_u32 v17, 50176, v17
    v_add_u32 v18, 50176, v18
    s_waitcnt vmcnt(5) lgkmcnt(7)
    v_mfma_f32_32x32x16_bf16 v[80:95], v[68:71], v[28:31], v[80:95]
    ds_read_b64_tr_b16 v[56:57], v16 offset:0
    ds_read_b64_tr_b16 v[58:59], v16 offset:768
    v_mfma_f32_32x32x16_bf16 v[96:111], v[72:75], v[28:31], v[96:111]
    ds_read_b64_tr_b16 v[60:61], v17 offset:0
    ds_read_b64_tr_b16 v[62:63], v17 offset:768
    v_mfma_f32_32x32x16_bf16 v[112:127], v[76:79], v[28:31], v[112:127]
    ds_read_b64_tr_b16 v[64:65], v18 offset:0
    ds_read_b64_tr_b16 v[66:67], v18 offset:768
    s_add_u32 s44, s44, 4096
    buffer_load_dwordx4 v[28:31], v13, s[32:35], s44 offen offset:0 sc1
    s_waitcnt vmcnt(5) lgkmcnt(7)
    v_mfma_f32_32x32x16_bf16 v[80:95], v[44:47], v[32:35], v[80:95]
    ds_read_b64_tr_b16 v[68:69], v16 offset:1536
    ds_read_b64_tr_b16 v[70:71], v16 offset:2304
    v_mfma_f32_32x32x16_bf16 v[96:111], v[48:51], v[32:35], v[96:111]
    ds_read_b64_tr_b16 v[72:73], v17 offset:1536
    ds_read_b64_tr_b16 v[74:75], v17 offset:2304
    v_mfma_f32_32x32x16_bf16 v[112:127], v[52:55], v[32:35], v[112:127]
    ds_read_b64_tr_b16 v[76:77], v18 offset:1536
    ds_read_b64_tr_b16 v[78:79], v18 offset:2304
    buffer_load_dwordx4 v[32:35], v13, s[32:35], s44 offen offset:1024 sc1
    s_waitcnt vmcnt(5) lgkmcnt(6)
    v_mfma_f32_32x32x16_bf16 v[80:95], v[56:59], v[36:39], v[80:95]
    ds_read_b64_tr_b16 v[44:45], v16 offset:3072
    ds_read_b64_tr_b16 v[46:47], v16 offset:3840
    v_mfma_f32_32x32x16_bf16 v[96:111], v[60:63], v[36:39], v[96:111]
    ds_read_b64_tr_b16 v[48:49], v17 offset:3072
    ds_read_b64_tr_b16 v[50:51], v17 offset:3840
    v_mfma_f32_32x32x16_bf16 v[112:127], v[64:67], v[36:39], v[112:127]
    ds_read_b64_tr_b16 v[52:53], v18 offset:3072
    ds_read_b64_tr_b16 v[54:55], v18 offset:3840
    buffer_load_dwordx4 v[36:39], v13, s[32:35], s44 offen offset:2048 sc1
    s_waitcnt vmcnt(5) lgkmcnt(6)
    v_mfma_f32_32x32x16_bf16 v[80:95], v[68:71], v[40:43], v[80:95]
    ds_read_b64_tr_b16 v[56:57], v16 offset:4608
    ds_read_b64_tr_b16 v[58:59], v16 offset:5376
    v_mfma_f32_32x32x16_bf16 v[96:111], v[72:75], v[40:43], v[96:111]
    ds_read_b64_tr_b16 v[60:61], v17 offset:4608
    ds_read_b64_tr_b16 v[62:63], v17 offset:5376
    v_mfma_f32_32x32x16_bf16 v[112:127], v[76:79], v[40:43], v[112:127]
    ds_read_b64_tr_b16 v[64:65], v18 offset:4608
    ds_read_b64_tr_b16 v[66:67], v18 offset:5376
    buffer_load_dwordx4 v[40:43], v13, s[32:35], s44 offen offset:3072 sc1
    v_mov_b32 v9, 29
    ds_write_b32 v8, v9
    s_waitcnt vmcnt(5) lgkmcnt(7)
    v_mfma_f32_32x32x16_bf16 v[80:95], v[44:47], v[20:23], v[80:95]
    ds_read_b64_tr_b16 v[68:69], v16 offset:12544
    ds_read_b64_tr_b16 v[70:71], v16 offset:13312
    v_mfma_f32_32x32x16_bf16 v[96:111], v[48:51], v[20:23], v[96:111]
    ds_read_b64_tr_b16 v[72:73], v17 offset:12544
    ds_read_b64_tr_b16 v[74:75], v17 offset:13312
    v_mfma_f32_32x32x16_bf16 v[112:127], v[52:55], v[20:23], v[112:127]
    ds_read_b64_tr_b16 v[76:77], v18 offset:12544
    ds_read_b64_tr_b16 v[78:79], v18 offset:13312
    s_add_u32 s44, s44, 4096
    buffer_load_dwordx4 v[20:23], v13, s[32:35], s44 offen offset:0 sc1
    s_waitcnt vmcnt(5) lgkmcnt(7)
    v_mfma_f32_32x32x16_bf16 v[80:95], v[56:59], v[24:27], v[80:95]
    ds_read_b64_tr_b16 v[44:45], v16 offset:14080
    ds_read_b64_tr_b16 v[46:47], v16 offset:14848
    v_mfma_f32_32x32x16_bf16 v[96:111], v[60:63], v[24:27], v[96:111]
    ds_read_b64_tr_b16 v[48:49], v17 offset:14080
    ds_read_b64_tr_b16 v[50:51], v17 offset:14848
    v_mfma_f32_32x32x16_bf16 v[112:127], v[64:67], v[24:27], v[112:127]
    ds_read_b64_tr_b16 v[52:53], v18 offset:14080
    ds_read_b64_tr_b16 v[54:55], v18 offset:14848
    buffer_load_dwordx4 v[24:27], v13, s[32:35], s44 offen offset:1024 sc1
    s_waitcnt vmcnt(5) lgkmcnt(6)
    v_mfma_f32_32x32x16_bf16 v[80:95], v[68:71], v[28:31], v[80:95]
    ds_read_b64_tr_b16 v[56:57], v16 offset:15616
    ds_read_b64_tr_b16 v[58:59], v16 offset:16384
    v_mfma_f32_32x32x16_bf16 v[96:111], v[72:75], v[28:31], v[96:111]
    ds_read_b64_tr_b16 v[60:61], v17 offset:15616
    ds_read_b64_tr_b16 v[62:63], v17 offset:16384
    v_mfma_f32_32x32x16_bf16 v[112:127], v[76:79], v[28:31], v[112:127]
    ds_read_b64_tr_b16 v[64:65], v18 offset:15616
    ds_read_b64_tr_b16 v[66:67], v18 offset:16384
    buffer_load_dwordx4 v[28:31], v13, s[32:35], s44 offen offset:2048 sc1
    s_waitcnt vmcnt(5) lgkmcnt(6)
    v_mfma_f32_32x32x16_bf16 v[80:95], v[44:47], v[32:35], v[80:95]
    ds_read_b64_tr_b16 v[68:69], v16 offset:17152
    ds_read_b64_tr_b16 v[70:71], v16 offset:17920
    v_mfma_f32_32x32x16_bf16 v[96:111], v[48:51], v[32:35], v[96:111]
    ds_read_b64_tr_b16 v[72:73], v17 offset:17152
    ds_read_b64_tr_b16 v[74:75], v17 offset:17920
    v_mfma_f32_32x32x16_bf16 v[112:127], v[52:55], v[32:35], v[112:127]
    ds_read_b64_tr_b16 v[76:77], v18 offset:17152
    ds_read_b64_tr_b16 v[78:79], v18 offset:17920
    buffer_load_dwordx4 v[32:35], v13, s[32:35], s44 offen offset:3072 sc1
    v_mov_b32 v9, 30
    ds_write_b32 v8, v9
    s_waitcnt vmcnt(5) lgkmcnt(7)
    v_mfma_f32_32x32x16_bf16 v[80:95], v[56:59], v[36:39], v[80:95]
    ds_read_b64_tr_b16 v[44:45], v16 offset:25088
    ds_read_b64_tr_b16 v[46:47], v16 offset:25856
    v_mfma_f32_32x32x16_bf16 v[96:111], v[60:63], v[36:39], v[96:111]
    ds_read_b64_tr_b16 v[48:49], v17 offset:25088
    ds_read_b64_tr_b16 v[50:51], v17 offset:25856
    v_mfma_f32_32x32x16_bf16 v[112:127], v[64:67], v[36:39], v[112:127]
    ds_read_b64_tr_b16 v[52:53], v18 offset:25088
    ds_read_b64_tr_b16 v[54:55], v18 offset:25856
    s_add_u32 s44, s44, 4096
    buffer_load_dwordx4 v[36:39], v13, s[32:35], s44 offen offset:0 sc1
    s_waitcnt vmcnt(5) lgkmcnt(7)
    v_mfma_f32_32x32x16_bf16 v[80:95], v[68:71], v[40:43], v[80:95]
    ds_read_b64_tr_b16 v[56:57], v16 offset:26624
    ds_read_b64_tr_b16 v[58:59], v16 offset:27392
    v_mfma_f32_32x32x16_bf16 v[96:111], v[72:75], v[40:43], v[96:111]
    ds_read_b64_tr_b16 v[60:61], v17 offset:26624
    ds_read_b64_tr_b16 v[62:63], v17 offset:27392
    v_mfma_f32_32x32x16_bf16 v[112:127], v[76:79], v[40:43], v[112:127]
    ds_read_b64_tr_b16 v[64:65], v18 offset:26624
    ds_read_b64_tr_b16 v[66:67], v18 offset:27392
    buffer_load_dwordx4 v[40:43], v13, s[32:35], s44 offen offset:1024 sc1
    ds_read_b32 v0, v19
    s_waitcnt vmcnt(5) lgkmcnt(7)
    v_mfma_f32_32x32x16_bf16 v[80:95], v[44:47], v[20:23], v[80:95]
    ds_read_b64_tr_b16 v[68:69], v16 offset:28160
    ds_read_b64_tr_b16 v[70:71], v16 offset:28928
    v_mfma_f32_32x32x16_bf16 v[96:111], v[48:51], v[20:23], v[96:111]
    ds_read_b64_tr_b16 v[72:73], v17 offset:28160
    ds_read_b64_tr_b16 v[74:75], v17 offset:28928
    v_mfma_f32_32x32x16_bf16 v[112:127], v[52:55], v[20:23], v[112:127]
    ds_read_b64_tr_b16 v[76:77], v18 offset:28160
    ds_read_b64_tr_b16 v[78:79], v18 offset:28928
    buffer_load_dwordx4 v[20:23], v13, s[32:35], s44 offen offset:2048 sc1
    s_waitcnt vmcnt(5) lgkmcnt(7)
    v_mfma_f32_32x32x16_bf16 v[80:95], v[56:59], v[24:27], v[80:95]
    ds_read_b64_tr_b16 v[44:45], v16 offset:29696
    ds_read_b64_tr_b16 v[46:47], v16 offset:30464
    v_mfma_f32_32x32x16_bf16 v[96:111], v[60:63], v[24:27], v[96:111]
    ds_read_b64_tr_b16 v[48:49], v17 offset:29696
    ds_read_b64_tr_b16 v[50:51], v17 offset:30464
    v_mfma_f32_32x32x16_bf16 v[112:127], v[64:67], v[24:27], v[112:127]
    ds_read_b64_tr_b16 v[52:53], v18 offset:29696
    ds_read_b64_tr_b16 v[54:55], v18 offset:30464
    buffer_load_dwordx4 v[24:27], v13, s[32:35], s44 offen offset:3072 sc1
    v_mov_b32 v9, 31
    ds_write_b32 v8, v9
    s_waitcnt lgkmcnt(13)
    v_cmp_gt_u32 vcc, 34, v0
    s_cbranch_vccz CK_52
    s_mov_b32 s59, 0x4000
LW_53:
    ds_read_b32 v9, v19
    s_waitcnt lgkmcnt(0)
    v_cmp_gt_u32 vcc, 34, v9
    s_cbranch_vccz LW_53_D
    s_sub_u32 s59, s59, 1
    s_cmp_lg_u32 s59, 0
    s_cbranch_scc1 LW_53
LW_53_D:
CK_52:
    s_waitcnt vmcnt(5) lgkmcnt(7)
    v_mfma_f32_32x32x16_bf16 v[80:95], v[68:71], v[28:31], v[80:95]
    ds_read_b64_tr_b16 v[56:57], v16 offset:37632
    ds_read_b64_tr_b16 v[58:59], v16 offset:38400
    v_mfma_f32_32x32x16_bf16 v[96:111], v[72:75], v[28:31], v[96:111]
    ds_read_b64_tr_b16 v[60:61], v17 offset:37632
    ds_read_b64_tr_b16 v[62:63], v17 offset:38400
    v_mfma_f32_32x32x16_bf16 v[112:127], v[76:79], v[28:31], v[112:127]
    ds_read_b64_tr_b16 v[64:65], v18 offset:37632
    ds_read_b64_tr_b16 v[66:67], v18 offset:38400
    s_waitcnt vmcnt(4) lgkmcnt(7)
    v_mfma_f32_32x32x16_bf16 v[80:95], v[44:47], v[32:35], v[80:95]
    ds_read_b64_tr_b16 v[68:69], v16 offset:39168
    ds_read_b64_tr_b16 v[70:71], v16 offset:39936
    v_mfma_f32_32x32x16_bf16 v[96:111], v[48:51], v[32:35], v[96:111]
    ds_read_b64_tr_b16 v[72:73], v17 offset:39168
    ds_read_b64_tr_b16 v[74:75], v17 offset:39936
    v_mfma_f32_32x32x16_bf16 v[112:127], v[52:55], v[32:35], v[112:127]
    ds_read_b64_tr_b16 v[76:77], v18 offset:39168
    ds_read_b64_tr_b16 v[78:79], v18 offset:39936
    s_waitcnt vmcnt(3) lgkmcnt(6)
    v_mfma_f32_32x32x16_bf16 v[80:95], v[56:59], v[36:39], v[80:95]
    ds_read_b64_tr_b16 v[44:45], v16 offset:40704
    ds_read_b64_tr_b16 v[46:47], v16 offset:41472
    v_mfma_f32_32x32x16_bf16 v[96:111], v[60:63], v[36:39], v[96:111]
    ds_read_b64_tr_b16 v[48:49], v17 offset:40704
    ds_read_b64_tr_b16 v[50:51], v17 offset:41472
    v_mfma_f32_32x32x16_bf16 v[112:127], v[64:67], v[36:39], v[112:127]
    ds_read_b64_tr_b16 v[52:53], v18 offset:40704
    ds_read_b64_tr_b16 v[54:55], v18 offset:41472
    s_waitcnt vmcnt(2) lgkmcnt(6)
    v_mfma_f32_32x32x16_bf16 v[80:95], v[68:71], v[40:43], v[80:95]
    ds_read_b64_tr_b16 v[56:57], v16 offset:42240
    ds_read_b64_tr_b16 v[58:59], v16 offset:43008
    v_mfma_f32_32x32x16_bf16 v[96:111], v[72:75], v[40:43], v[96:111]
    ds_read_b64_tr_b16 v[60:61], v17 offset:42240
    ds_read_b64_tr_b16 v[62:63], v17 offset:43008
    v_mfma_f32_32x32x16_bf16 v[112:127], v[76:79], v[40:43], v[112:127]
    ds_read_b64_tr_b16 v[64:65], v18 offset:42240
    ds_read_b64_tr_b16 v[66:67], v18 offset:43008
    s_waitcnt vmcnt(1) lgkmcnt(6)
    v_mfma_f32_32x32x16_bf16 v[80:95], v[44:47], v[20:23], v[80:95]
    v_mfma_f32_32x32x16_bf16 v[96:111], v[48:51], v[20:23], v[96:111]
    v_mfma_f32_32x32x16_bf16 v[112:127], v[52:55], v[20:23], v[112:127]
    s_waitcnt vmcnt(0) lgkmcnt(0)
    v_mfma_f32_32x32x16_bf16 v[80:95], v[56:59], v[24:27], v[80:95]
    v_mfma_f32_32x32x16_bf16 v[96:111], v[60:63], v[24:27], v[96:111]
    v_mfma_f32_32x32x16_bf16 v[112:127], v[64:67], v[24:27], v[112:127]
    s_setprio 0
P3_SKIP:
    v_mov_b32 v9, 32
    ds_write_b32 v8, v9
    s_add_u32 s36, s28, 0x800000
    s_addc_u32 s37, s29, 0
    s_mov_b32 s38, 0x560000
    s_mov_b32 s39, 0x00020000
    v_lshlrev_b32 v16, 4, v3
    v_add_u32 v16, 159744, v16
    v_lshlrev_b32 v17, 3, v2
    s_lshl_b32 s58, s3, 8
    s_add_u32 s58, s58, 160512
    v_add_u32 v17, s58, v17
    s_mov_b32 s60, 0xbdd2d3e8
    s_mov_b32 s61, 0xbdd2d3e8
    v_mov_b32 v22, 0xc0135761
    v_mov_b32 v23, 0xc0135761
    s_lshr_b32 s44, s2, 3
    s_lshr_b32 s58, s2, 5
    s_lshl_b32 s58, 1, s58
    s_and_b32 s58, s58, 136
    s_cselect_b32 s58, 16, 0
    s_xor_b32 s44, s44, s58
    s_mul_i32 s44, s44, 3
    s_mul_i32 s43, s43, 88064
    s_lshl_b32 s58, s44, 10
    s_add_u32 s43, s43, s58
    s_mov_b32 s62, 0
    s_mov_b32 s59, 0x4000
LW_54:
    ds_read_b32 v9, v19
    s_waitcnt lgkmcnt(0)
    v_cmp_gt_u32 vcc, 36, v9
    s_cbranch_vccz LW_54_D
    s_sub_u32 s59, s59, 1
    s_cmp_lg_u32 s59, 0
    s_cbranch_scc1 LW_54
LW_54_D:
    ds_read_b64 v[18:19], v17
    s_waitcnt lgkmcnt(0)
    v_mov_b32 v20, v19
    v_mov_b32 v21, v19
    v_mov_b32 v19, v18
EPI3:
    s_cmp_ge_u32 s44, 86
    s_cbranch_scc1 EPD3
    ds_read_b128 v[24:27], v16 offset:0
    ds_read_b128 v[40:43], v16 offset:128
    ds_read_b128 v[28:31], v16 offset:32
    ds_read_b128 v[44:47], v16 offset:160
    ds_read_b128 v[32:35], v16 offset:64
    ds_read_b128 v[48:51], v16 offset:192
    ds_read_b128 v[36:39], v16 offset:96
    ds_read_b128 v[52:55], v16 offset:224
    v_add_u32 v16, 256, v16
    s_waitcnt lgkmcnt(0)
    s_set_gpr_idx_on s62, 0x4
    v_pk_fma_f32 v[56:57], v[24:25], v[20:21], v[80:81]
    v_pk_fma_f32 v[58:59], v[26:27], v[20:21], v[82:83]
    v_pk_fma_f32 v[60:61], v[28:29], v[20:21], v[84:85]
    v_pk_fma_f32 v[62:63], v[30:31], v[20:21], v[86:87]
    v_pk_fma_f32 v[64:65], v[32:33], v[20:21], v[88:89]
    v_pk_fma_f32 v[66:67], v[34:35], v[20:21], v[90:91]
    v_pk_fma_f32 v[68:69], v[36:37], v[20:21], v[92:93]
    v_pk_fma_f32 v[70:71], v[38:39], v[20:21], v[94:95]
    s_set_gpr_idx_off
    v_pk_fma_f32 v[56:57], v[56:57], v[18:19], v[40:41]
    v_pk_fma_f32 v[58:59], v[58:59], v[18:19], v[42:43]
    v_pk_fma_f32 v[60:61], v[60:61], v[18:19], v[44:45]
    v_pk_fma_f32 v[62:63], v[62:63], v[18:19], v[46:47]
    v_pk_fma_f32 v[64:65], v[64:65], v[18:19], v[48:49]
    v_pk_fma_f32 v[66:67], v[66:67], v[18:19], v[50:51]
    v_pk_fma_f32 v[68:69], v[68:69], v[18:19], v[52:53]
    v_pk_fma_f32 v[70:71], v[70:71], v[18:19], v[54:55]
    v_pk_mul_f32 v[72:73], v[56:57], v[56:57]
    v_pk_mul_f32 v[74:75], v[58:59], v[58:59]
    v_pk_mul_f32 v[76:77], v[60:61], v[60:61]
    v_pk_mul_f32 v[78:79], v[62:63], v[62:63]
    v_pk_fma_f32 v[72:73], v[72:73], s[60:61], v[22:23]
    v_pk_fma_f32 v[74:75], v[74:75], s[60:61], v[22:23]
    v_pk_fma_f32 v[76:77], v[76:77], s[60:61], v[22:23]
    v_pk_fma_f32 v[78:79], v[78:79], s[60:61], v[22:23]
    v_pk_mul_f32 v[72:73], v[72:73], v[56:57]
    v_pk_mul_f32 v[74:75], v[74:75], v[58:59]
    v_pk_mul_f32 v[76:77], v[76:77], v[60:61]
    v_pk_mul_f32 v[78:79], v[78:79], v[62:63]
    v_exp_f32 v72, v72
    v_exp_f32 v73, v73
    v_pk_mul_f32 v[56:57], v[56:57], v[64:65]
    v_exp_f32 v74, v74
    v_exp_f32 v75, v75
    v_pk_mul_f32 v[58:59], v[58:59], v[66:67]
    v_exp_f32 v76, v76
    v_exp_f32 v77, v77
    v_pk_mul_f32 v[60:61], v[60:61], v[68:69]
    v_exp_f32 v78, v78
    v_exp_f32 v79, v79
    v_pk_mul_f32 v[62:63], v[62:63], v[70:71]
    v_pk_add_f32 v[72:73], v[72:73], 1.0 op_sel_hi:[1,0]
    v_pk_add_f32 v[74:75], v[74:75], 1.0 op_sel_hi:[1,0]
    v_pk_add_f32 v[76:77], v[76:77], 1.0 op_sel_hi:[1,0]
    v_pk_add_f32 v[78:79], v[78:79], 1.0 op_sel_hi:[1,0]
    v_rcp_f32 v72, v72
    v_rcp_f32 v73, v73
    v_rcp_f32 v74, v74
    v_rcp_f32 v75, v75
    v_rcp_f32 v76, v76
    v_rcp_f32 v77, v77
    v_rcp_f32 v78, v78
    v_rcp_f32 v79, v79
    v_pk_mul_f32 v[56:57], v[56:57], v[72:73]
    v_pk_mul_f32 v[58:59], v[58:59], v[74:75]
    v_pk_mul_f32 v[60:61], v[60:61], v[76:77]
    v_pk_mul_f32 v[62:63], v[62:63], v[78:79]
    v_cvt_pk_bf16_f32 v64, v56, v57
    v_cvt_pk_bf16_f32 v65, v58, v59
    v_cvt_pk_bf16_f32 v66, v60, v61
    v_cvt_pk_bf16_f32 v67, v62, v63
    buffer_store_dwordx4 v[64:67], v13, s[36:39], s43 offen sc1
    s_add_u32 s44, s44, 1
    s_add_u32 s43, s43, 1024
    s_add_u32 s62, s62, 16
    s_cmp_lt_u32 s62, 48
    s_cbranch_scc1 EPI3
EPD3:
    s_mul_i32 s62, s56, 22
    s_mul_i32 s63, s56, 20
    s_cmp_eq_u32 s56, 3
    s_subb_u32 s62, s62, 0
    s_cmp_eq_u32 s56, 3
    s_subb_u32 s63, s63, 0
    s_lshl_b32 s63, s63, 11
    v_add_u32 v16, s63, v12
    v_xor_b32 v17, 64, v16
    s_lshl_b32 s43, s54, 1
    s_add_u32 s43, s43, s57
    s_mul_i32 s44, s43, 86
    s_add_u32 s44, s44, s62
    s_lshl_b32 s44, s44, 10
    s_mov_b32 s47, s44
    s_waitcnt vmcnt(0)
    v_mov_b32 v9, 33
    ds_write_b32 v8, v9
    v_and_b32 v18, 3, v1
    v_lshlrev_b32 v18, 2, v18
    v_add_u32 v18, 163360, v18
    s_mov_b32 s59, 0x4000
LW_55:
    ds_read_b32 v9, v18
    s_waitcnt lgkmcnt(0)
    v_cmp_gt_u32 vcc, 37, v9
    s_cbranch_vccz LW_55_D
    s_sub_u32 s59, s59, 1
    s_cmp_lg_u32 s59, 0
    s_cbranch_scc1 LW_55
LW_55_D:
    ds_read_b64_tr_b16 v[64:65], v16 offset:0
    ds_read_b64_tr_b16 v[66:67], v16 offset:1024
    ds_read_b64_tr_b16 v[68:69], v17 offset:0
    ds_read_b64_tr_b16 v[70:71], v17 offset:1024
    ds_read_b64_tr_b16 v[72:73], v16 offset:2048
    ds_read_b64_tr_b16 v[74:75], v16 offset:3072
    ds_read_b64_tr_b16 v[76:77], v17 offset:2048
    ds_read_b64_tr_b16 v[78:79], v17 offset:3072
    ds_read_b64_tr_b16 v[80:81], v16 offset:4096
    ds_read_b64_tr_b16 v[82:83], v16 offset:5120
    ds_read_b64_tr_b16 v[84:85], v17 offset:4096
    ds_read_b64_tr_b16 v[86:87], v17 offset:5120
    v_mov_b32 v9, 34
    ds_write_b32 v8, v9
    s_cmp_lt_u32 s56, 2
    s_cselect_b32 s60, 1024, 0
    s_cselect_b32 s62, 22, 21
    s_bfm_b32 s62, s62, 0
    v_mov_b32 v10, 163376
    s_mov_b32 s59, 0x4000
LW_56:
    ds_read_b32 v9, v10
    s_waitcnt lgkmcnt(0)
    v_cmp_gt_u32 vcc, 13, v9
    s_cbranch_vccz LW_56_D
    s_sub_u32 s59, s59, 1
    s_cmp_lg_u32 s59, 0
    s_cbranch_scc1 LW_56
LW_56_D:
    buffer_load_dwordx4 v[24:27], v13, s[36:39], s44 offen offset:0 sc1
    buffer_load_dwordx4 v[28:31], v13, s[36:39], s44 offen offset:1024 sc1
    buffer_load_dwordx4 v[32:35], v13, s[36:39], s44 offen offset:2048 sc1
    buffer_load_dwordx4 v[36:39], v13, s[36:39], s44 offen offset:3072 sc1
    s_add_u32 s44, s44, 4096
    buffer_load_dwordx4 v[40:43], v13, s[36:39], s44 offen offset:0 sc1
    buffer_load_dwordx4 v[44:47], v13, s[36:39], s44 offen offset:1024 sc1
    buffer_load_dwordx4 v[48:51], v13, s[36:39], s44 offen offset:2048 sc1
    buffer_load_dwordx4 v[52:55], v13, s[36:39], s44 offen offset:3072 sc1
    s_add_u32 s44, s44, 4096
    buffer_load_dwordx4 v[56:59], v13, s[36:39], s44 offen offset:0 sc1
    buffer_load_dwordx4 v[60:63], v13, s[36:39], s44 offen offset:1024 sc1
    s_mul_i32 s61, s57, 6144
    s_add_u32 s61, s61, 4096
    s_add_u32 s62, s61, s63
    v_add_u32 v20, s62, v13
    s_sub_u32 s62, s56, 1
    s_and_b32 s62, s62, 3
    s_mul_i32 s63, s62, 20
    s_cmp_eq_u32 s62, 3
    s_subb_u32 s63, s63, 0
    s_lshl_b32 s63, s63, 11
    s_add_u32 s63, s63, s61
    v_add_u32 v21, s63, v13
    s_sub_u32 s62, s56, 2
    s_and_b32 s62, s62, 3
    s_mul_i32 s63, s62, 20
    s_cmp_eq_u32 s62, 3
    s_subb_u32 s63, s63, 0
    s_lshl_b32 s63, s63, 11
    s_add_u32 s63, s63, s61
    v_add_u32 v22, s63, v13
    s_sub_u32 s62, s56, 3
    s_and_b32 s62, s62, 3
    s_mul_i32 s63, s62, 20
    s_cmp_eq_u32 s62, 3
    s_subb_u32 s63, s63, 0
    s_lshl_b32 s63, s63, 11
    s_add_u32 s63, s63, s61
    v_add_u32 v23, s63, v13
    s_waitcnt vmcnt(9) lgkmcnt(9)
    v_mfma_f32_32x32x16_bf16 v[96:111], v[64:67], v[24:27], 0
    v_mfma_f32_32x32x16_bf16 v[112:127], v[68:71], v[24:27], 0
    ds_read_b64_tr_b16 v[88:89], v16 offset:6144
    ds_read_b64_tr_b16 v[90:91], v16 offset:7168
    ds_read_b64_tr_b16 v[92:93], v17 offset:6144
    ds_read_b64_tr_b16 v[94:95], v17 offset:7168
    buffer_load_dwordx4 v[24:27], v13, s[36:39], s44 offen offset:2048 sc1
    s_waitcnt vmcnt(9) lgkmcnt(9)
    v_mfma_f32_32x32x16_bf16 v[96:111], v[72:75], v[28:31], v[96:111]
    v_mfma_f32_32x32x16_bf16 v[112:127], v[76:79], v[28:31], v[112:127]
    ds_read_b64_tr_b16 v[64:65], v16 offset:8192
    ds_read_b64_tr_b16 v[66:67], v16 offset:9216
    ds_read_b64_tr_b16 v[68:69], v17 offset:8192
    ds_read_b64_tr_b16 v[70:71], v17 offset:9216
    buffer_load_dwordx4 v[28:31], v13, s[36:39], s44 offen offset:3072 sc1
    s_waitcnt vmcnt(9) lgkmcnt(9)
    v_mfma_f32_32x32x16_bf16 v[96:111], v[80:83], v[32:35], v[96:111]
    v_mfma_f32_32x32x16_bf16 v[112:127], v[84:87], v[32:35], v[112:127]
    ds_read_b64_tr_b16 v[72:73], v16 offset:10240
    ds_read_b64_tr_b16 v[74:75], v16 offset:11264
    ds_read_b64_tr_b16 v[76:77], v17 offset:10240
    ds_read_b64_tr_b16 v[78:79], v17 offset:11264
    s_add_u32 s44, s44, 4096
    buffer_load_dwordx4 v[32:35], v13, s[36:39], s44 offen offset:0 sc1
    s_waitcnt vmcnt(9) lgkmcnt(8)
    v_mfma_f32_32x32x16_bf16 v[96:111], v[88:91], v[36:39], v[96:111]
    v_mfma_f32_32x32x16_bf16 v[112:127], v[92:95], v[36:39], v[112:127]
    ds_read_b64_tr_b16 v[80:81], v16 offset:12288
    ds_read_b64_tr_b16 v[82:83], v16 offset:13312
    ds_read_b64_tr_b16 v[84:85], v17 offset:12288
    ds_read_b64_tr_b16 v[86:87], v17 offset:13312
    buffer_load_dwordx4 v[36:39], v13, s[36:39], s44 offen offset:1024 sc1
    s_waitcnt vmcnt(9) lgkmcnt(8)
    v_mfma_f32_32x32x16_bf16 v[96:111], v[64:67], v[40:43], v[96:111]
    v_mfma_f32_32x32x16_bf16 v[112:127], v[68:71], v[40:43], v[112:127]
    ds_read_b64_tr_b16 v[88:89], v16 offset:14336
    ds_read_b64_tr_b16 v[90:91], v16 offset:15360
    ds_read_b64_tr_b16 v[92:93], v17 offset:14336
    ds_read_b64_tr_b16 v[94:95], v17 offset:15360
    buffer_load_dwordx4 v[40:43], v13, s[36:39], s44 offen offset:2048 sc1
    s_waitcnt vmcnt(9) lgkmcnt(8)
    v_mfma_f32_32x32x16_bf16 v[96:111], v[72:75], v[44:47], v[96:111]
    v_mfma_f32_32x32x16_bf16 v[112:127], v[76:79], v[44:47], v[112:127]
    ds_read_b64_tr_b16 v[64:65], v16 offset:16384
    ds_read_b64_tr_b16 v[66:67], v16 offset:17408
    ds_read_b64_tr_b16 v[68:69], v17 offset:16384
    ds_read_b64_tr_b16 v[70:71], v17 offset:17408
    buffer_load_dwordx4 v[44:47], v13, s[36:39], s44 offen offset:3072 sc1
    s_waitcnt vmcnt(9) lgkmcnt(8)
    v_mfma_f32_32x32x16_bf16 v[96:111], v[80:83], v[48:51], v[96:111]
    v_mfma_f32_32x32x16_bf16 v[112:127], v[84:87], v[48:51], v[112:127]
    ds_read_b64_tr_b16 v[72:73], v16 offset:18432
    ds_read_b64_tr_b16 v[74:75], v16 offset:19456
    ds_read_b64_tr_b16 v[76:77], v17 offset:18432
    ds_read_b64_tr_b16 v[78:79], v17 offset:19456
    s_add_u32 s44, s44, 4096
    buffer_load_dwordx4 v[48:51], v13, s[36:39], s44 offen offset:0 sc1
    v_mov_b32 v9, 35
    ds_write_b32 v8, v9
    s_waitcnt vmcnt(9) lgkmcnt(9)
    v_mfma_f32_32x32x16_bf16 v[96:111], v[88:91], v[52:55], v[96:111]
    v_mfma_f32_32x32x16_bf16 v[112:127], v[92:95], v[52:55], v[112:127]
    ds_read_b64_tr_b16 v[80:81], v16 offset:20480
    ds_read_b64_tr_b16 v[82:83], v16 offset:21504
    ds_read_b64_tr_b16 v[84:85], v17 offset:20480
    ds_read_b64_tr_b16 v[86:87], v17 offset:21504
    buffer_load_dwordx4 v[52:55], v13, s[36:39], s44 offen offset:1024 sc1
    s_waitcnt vmcnt(9) lgkmcnt(9)
    v_mfma_f32_32x32x16_bf16 v[96:111], v[64:67], v[56:59], v[96:111]
    v_mfma_f32_32x32x16_bf16 v[112:127], v[68:71], v[56:59], v[112:127]
    ds_read_b64_tr_b16 v[88:89], v16 offset:22528
    ds_read_b64_tr_b16 v[90:91], v16 offset:23552
    ds_read_b64_tr_b16 v[92:93], v17 offset:22528
    ds_read_b64_tr_b16 v[94:95], v17 offset:23552
    buffer_load_dwordx4 v[56:59], v13, s[36:39], s44 offen offset:2048 sc1
    s_waitcnt vmcnt(9) lgkmcnt(9)
    v_mfma_f32_32x32x16_bf16 v[96:111], v[72:75], v[60:63], v[96:111]
    v_mfma_f32_32x32x16_bf16 v[112:127], v[76:79], v[60:63], v[112:127]
    ds_read_b64_tr_b16 v[64:65], v16 offset:24576
    ds_read_b64_tr_b16 v[66:67], v16 offset:25600
    ds_read_b64_tr_b16 v[68:69], v17 offset:24576
    ds_read_b64_tr_b16 v[70:71], v17 offset:25600
    s_add_u32 s43, s44, s60
    buffer_load_dwordx4 v[60:63], v13, s[36:39], s43 offen offset:3072 sc1
    s_waitcnt vmcnt(9) lgkmcnt(8)
    v_mfma_f32_32x32x16_bf16 v[96:111], v[80:83], v[24:27], v[96:111]
    v_mfma_f32_32x32x16_bf16 v[112:127], v[84:87], v[24:27], v[112:127]
    ds_read_b64_tr_b16 v[72:73], v16 offset:26624
    ds_read_b64_tr_b16 v[74:75], v16 offset:27648
    ds_read_b64_tr_b16 v[76:77], v17 offset:26624
    ds_read_b64_tr_b16 v[78:79], v17 offset:27648
    s_add_u32 s43, s43, 1024
    buffer_load_dwordx4 v[24:27], v13, s[36:39], s43 offen offset:3072 sc1
    s_waitcnt vmcnt(9) lgkmcnt(8)
    v_mfma_f32_32x32x16_bf16 v[96:111], v[88:91], v[28:31], v[96:111]
    v_mfma_f32_32x32x16_bf16 v[112:127], v[92:95], v[28:31], v[112:127]
    ds_read_b64_tr_b16 v[80:81], v16 offset:28672
    ds_read_b64_tr_b16 v[82:83], v16 offset:29696
    ds_read_b64_tr_b16 v[84:85], v17 offset:28672
    ds_read_b64_tr_b16 v[86:87], v17 offset:29696
    buffer_load_dwordx4 v[28:31], v13, s[36:39], s44 offen offset:3072 sc1
    s_waitcnt vmcnt(9) lgkmcnt(8)
    v_mfma_f32_32x32x16_bf16 v[96:111], v[64:67], v[32:35], v[96:111]
    v_mfma_f32_32x32x16_bf16 v[112:127], v[68:71], v[32:35], v[112:127]
    ds_read_b64_tr_b16 v[88:89], v16 offset:30720
    ds_read_b64_tr_b16 v[90:91], v16 offset:31744
    ds_read_b64_tr_b16 v[92:93], v17 offset:30720
    ds_read_b64_tr_b16 v[94:95], v17 offset:31744
    s_waitcnt vmcnt(8) lgkmcnt(8)
    v_mfma_f32_32x32x16_bf16 v[96:111], v[72:75], v[36:39], v[96:111]
    v_mfma_f32_32x32x16_bf16 v[112:127], v[76:79], v[36:39], v[112:127]
    ds_read_b64_tr_b16 v[64:65], v16 offset:32768
    ds_read_b64_tr_b16 v[66:67], v16 offset:33792
    ds_read_b64_tr_b16 v[68:69], v17 offset:32768
    ds_read_b64_tr_b16 v[70:71], v17 offset:33792
    ds_read_b32 v19, v18
    s_waitcnt vmcnt(7) lgkmcnt(9)
    v_mfma_f32_32x32x16_bf16 v[96:111], v[80:83], v[40:43], v[96:111]
    v_mfma_f32_32x32x16_bf16 v[112:127], v[84:87], v[40:43], v[112:127]
    ds_read_b64_tr_b16 v[72:73], v16 offset:34816
    ds_read_b64_tr_b16 v[74:75], v16 offset:35840
    ds_read_b64_tr_b16 v[76:77], v17 offset:34816
    ds_read_b64_tr_b16 v[78:79], v17 offset:35840
    s_waitcnt vmcnt(6) lgkmcnt(9)
    v_mfma_f32_32x32x16_bf16 v[96:111], v[88:91], v[44:47], v[96:111]
    v_mfma_f32_32x32x16_bf16 v[112:127], v[92:95], v[44:47], v[112:127]
    ds_read_b64_tr_b16 v[80:81], v16 offset:36864
    ds_read_b64_tr_b16 v[82:83], v16 offset:37888
    ds_read_b64_tr_b16 v[84:85], v17 offset:36864
    ds_read_b64_tr_b16 v[86:87], v17 offset:37888
    s_waitcnt lgkmcnt(8)
    v_cmp_gt_u32 vcc, 38, v19
    s_cbranch_vccz CK_57
    s_mov_b32 s59, 0x4000
LW_58:
    ds_read_b32 v9, v18
    s_waitcnt lgkmcnt(0)
    v_cmp_gt_u32 vcc, 38, v9
    s_cbranch_vccz LW_58_D
    s_sub_u32 s59, s59, 1
    s_cmp_lg_u32 s59, 0
    s_cbranch_scc1 LW_58
LW_58_D:
CK_57:
    s_waitcnt vmcnt(5) lgkmcnt(9)
    v_mfma_f32_32x32x16_bf16 v[96:111], v[64:67], v[48:51], v[96:111]
    v_mfma_f32_32x32x16_bf16 v[112:127], v[68:71], v[48:51], v[112:127]
    ds_read_b64_tr_b16 v[88:89], v16 offset:0
    ds_read_b64_tr_b16 v[90:91], v16 offset:1024
    ds_read_b64_tr_b16 v[92:93], v17 offset:0
    ds_read_b64_tr_b16 v[94:95], v17 offset:1024
    s_waitcnt vmcnt(4) lgkmcnt(8)
    v_mfma_f32_32x32x16_bf16 v[96:111], v[72:75], v[52:55], v[96:111]
    v_mfma_f32_32x32x16_bf16 v[112:127], v[76:79], v[52:55], v[112:127]
    ds_read_b64_tr_b16 v[64:65], v16 offset:2048
    ds_read_b64_tr_b16 v[66:67], v16 offset:3072
    ds_read_b64_tr_b16 v[68:69], v17 offset:2048
    ds_read_b64_tr_b16 v[70:71], v17 offset:3072
    s_waitcnt vmcnt(3) lgkmcnt(8)
    v_mfma_f32_32x32x16_bf16 v[96:111], v[80:83], v[56:59], v[96:111]
    v_mfma_f32_32x32x16_bf16 v[112:127], v[84:87], v[56:59], v[112:127]
    ds_read_b64_tr_b16 v[72:73], v16 offset:38912
    ds_read_b64_tr_b16 v[74:75], v16 offset:39936
    ds_read_b64_tr_b16 v[76:77], v17 offset:38912
    ds_read_b64_tr_b16 v[78:79], v17 offset:39936
    s_waitcnt vmcnt(2) lgkmcnt(8)
    v_mfma_f32_32x32x16_bf16 v[96:111], v[88:91], v[60:63], v[96:111]
    v_mfma_f32_32x32x16_bf16 v[112:127], v[92:95], v[60:63], v[112:127]
    s_waitcnt vmcnt(1) lgkmcnt(4)
    v_mfma_f32_32x32x16_bf16 v[96:111], v[64:67], v[24:27], v[96:111]
    v_mfma_f32_32x32x16_bf16 v[112:127], v[68:71], v[24:27], v[112:127]
    s_cmp_ge_u32 s56, 2
    s_cbranch_scc1 M4D
    s_waitcnt vmcnt(0) lgkmcnt(0)
    v_mfma_f32_32x32x16_bf16 v[96:111], v[72:75], v[28:31], v[96:111]
    v_mfma_f32_32x32x16_bf16 v[112:127], v[76:79], v[28:31], v[112:127]
M4D:
    s_waitcnt vmcnt(0) lgkmcnt(0)
    ds_read_b128 v[48:51], v14 offset:512
    ds_read_b128 v[52:55], v14 offset:544
    s_xor_b32 s58, s3, 4
    s_lshl_b32 s58, s58, 2
    s_add_u32 s58, s58, 163328
    v_mov_b32 v10, s58
    s_mov_b32 s59, 0x4000
LW_59:
    ds_read_b32 v9, v10
    s_waitcnt lgkmcnt(0)
    v_cmp_gt_u32 vcc, 35, v9
    s_cbranch_vccz LW_59_D
    s_sub_u32 s59, s59, 1
    s_cmp_lg_u32 s59, 0
    s_cbranch_scc1 LW_59
LW_59_D:
    s_nop 7
    ds_write_b128 v20, v[104:107] offset:0
    ds_write_b128 v20, v[108:111] offset:1024
    ds_write_b128 v20, v[112:115] offset:2048
    ds_write_b128 v20, v[116:119] offset:3072
    ds_write_b128 v20, v[120:123] offset:4096
    ds_write_b128 v20, v[124:127] offset:5120
    v_mov_b32 v9, 36
    ds_write_b32 v8, v9
    v_and_b32 v10, 3, v1
    v_lshlrev_b32 v10, 2, v10
    v_add_u32 v10, 163328, v10
    s_lshl_b32 s59, s57, 4
    v_add_u32 v10, s59, v10
    s_mov_b32 s59, 0x4000
LW_60:
    ds_read_b32 v9, v10
    s_waitcnt lgkmcnt(0)
    v_cmp_gt_u32 vcc, 36, v9
    s_cbranch_vccz LW_60_D
    s_sub_u32 s59, s59, 1
    s_cmp_lg_u32 s59, 0
    s_cbranch_scc1 LW_60
LW_60_D:
    ds_read_b128 v[64:67], v21 offset:0
    ds_read_b128 v[68:71], v21 offset:1024
    ds_read_b128 v[72:75], v22 offset:2048
    ds_read_b128 v[76:79], v22 offset:3072
    ds_read_b128 v[80:83], v23 offset:4096
    ds_read_b128 v[84:87], v23 offset:5120
    s_waitcnt lgkmcnt(2)
    v_pk_add_f32 v[64:65], v[64:65], v[72:73]
    v_pk_add_f32 v[66:67], v[66:67], v[74:75]
    v_pk_add_f32 v[68:69], v[68:69], v[76:77]
    v_pk_add_f32 v[70:71], v[70:71], v[78:79]
    s_waitcnt lgkmcnt(0)
    v_pk_add_f32 v[96:97], v[96:97], v[80:81]
    v_pk_add_f32 v[98:99], v[98:99], v[82:83]
    v_pk_add_f32 v[100:101], v[100:101], v[84:85]
    v_pk_add_f32 v[102:103], v[102:103], v[86:87]
    v_pk_add_f32 v[96:97], v[96:97], v[64:65]
    v_pk_add_f32 v[98:99], v[98:99], v[66:67]
    v_pk_add_f32 v[100:101], v[100:101], v[68:69]
    v_pk_add_f32 v[102:103], v[102:103], v[70:71]
    s_mov_b32 s32, s24
    s_mov_b32 s33, s25
    s_mov_b32 s34, 0x200000
    s_mov_b32 s35, 0x00020000
    v_cvt_pk_bf16_f32 v56, v96, v97
    v_cvt_pk_bf16_f32 v57, v98, v99
    v_cvt_pk_bf16_f32 v58, v100, v101
    v_cvt_pk_bf16_f32 v59, v102, v103
    v_lshlrev_b32 v96, 16, v56
    v_and_b32 v97, 0xffff0000, v56
    v_lshlrev_b32 v98, 16, v57
    v_and_b32 v99, 0xffff0000, v57
    v_lshlrev_b32 v100, 16, v58
    v_and_b32 v101, 0xffff0000, v58
    v_lshlrev_b32 v102, 16, v59
    v_and_b32 v103, 0xffff0000, v59
    v_pk_mul_f32 v[96:97], v[96:97], v[48:49]
    v_pk_mul_f32 v[98:99], v[98:99], v[50:51]
    v_pk_mul_f32 v[100:101], v[100:101], v[52:53]
    v_pk_mul_f32 v[102:103], v[102:103], v[54:55]
    v_lshlrev_b32 v64, 16, v4
    v_and_b32 v65, 0xffff0000, v4
    v_lshlrev_b32 v66, 16, v5
    v_and_b32 v67, 0xffff0000, v5
    v_lshlrev_b32 v68, 16, v6
    v_and_b32 v69, 0xffff0000, v6
    v_lshlrev_b32 v70, 16, v7
    v_and_b32 v71, 0xffff0000, v7
    v_cvt_pk_bf16_f32 v56, v96, v97
    v_cvt_pk_bf16_f32 v57, v98, v99
    v_cvt_pk_bf16_f32 v58, v100, v101
    v_cvt_pk_bf16_f32 v59, v102, v103
    v_lshlrev_b32 v96, 16, v56
    v_and_b32 v97, 0xffff0000, v56
    v_lshlrev_b32 v98, 16, v57
    v_and_b32 v99, 0xffff0000, v57
    v_lshlrev_b32 v100, 16, v58
    v_and_b32 v101, 0xffff0000, v58
    v_lshlrev_b32 v102, 16, v59
    v_and_b32 v103, 0xffff0000, v59
    v_pk_add_f32 v[96:97], v[96:97], v[64:65]
    v_pk_add_f32 v[98:99], v[98:99], v[66:67]
    v_pk_add_f32 v[100:101], v[100:101], v[68:69]
    v_pk_add_f32 v[102:103], v[102:103], v[70:71]
    v_cvt_pk_bf16_f32 v56, v96, v97
    v_cvt_pk_bf16_f32 v57, v98, v99
    v_cvt_pk_bf16_f32 v58, v100, v101
    v_cvt_pk_bf16_f32 v59, v102, v103
    s_nop 0
    v_permlane32_swap_b32 v56, v58
    v_permlane32_swap_b32 v57, v59
    buffer_store_dwordx4 v[56:59], v15, s[32:35], s46 offen
    s_endpgm
MK_AUX:
    v_lshrrev_b32 v2, 3, v1
    v_and_b32 v3, 7, v1
    v_bfe_u32 v4, v1, 4, 1
    v_lshlrev_b32 v4, 2, v4
    v_xor_b32 v4, v3, v4
    v_lshlrev_b32 v4, 4, v4
    v_mul_u32_u24 v12, 3072, v2
    v_add_u32 v12, v12, v4
    v_add_u32 v13, 24576, v12
    v_lshl_add_u32 v14, v2, 10, v4
    s_mul_i32 s40, s56, 49152
    s_lshl_b32 s58, s55, 7
    s_add_u32 s40, s40, s58
    s_lshl_b32 s41, s56, 11
    s_waitcnt lgkmcnt(0)
    s_mov_b32 s32, s6
    s_mov_b32 s33, s7
    s_mov_b32 s34, 0x180000
    s_mov_b32 s35, 0x00020000
    v_and_b32 v5, 3, v1
    v_lshlrev_b32 v5, 2, v5
    v_add_u32 v5, 163328, v5
    v_and_b32 v6, 3, v1
    v_lshlrev_b32 v6, 2, v6
    v_add_u32 v6, 163344, v6
    v_and_b32 v7, 7, v1
    v_lshlrev_b32 v7, 2, v7
    v_add_u32 v7, 163328, v7
    v_and_b32 v15, 3, v1
    v_lshlrev_b32 v15, 2, v15
    v_add_u32 v15, 163360, v15
    s_mov_b32 s36, s8
    s_mov_b32 s37, s9
    s_mov_b32 s38, 0x4000
    s_mov_b32 s39, 0x00020000
    v_lshlrev_b32 v16, 4, v1
    s_and_b32 s58, s56, 1
    s_lshl_b32 s58, s58, 10
    s_add_u32 m0, s58, 160768
    s_lshl_b32 s59, s55, 11
    s_add_u32 s58, s58, s59
    s_mov_b32 s59, 0x4000
LW_61:
    ds_read_b32 v9, v7
    s_waitcnt lgkmcnt(0)
    v_cmp_gt_u32 vcc, 2, v9
    s_cbranch_vccz LW_61_D
    s_sub_u32 s59, s59, 1
    s_cmp_lg_u32 s59, 0
    s_cbranch_scc1 LW_61
LW_61_D:
    s_cmp_lt_u32 s2, 32
    s_cbranch_scc0 AX_NH
    v_mov_b32 v10, 163376
    s_mov_b32 s59, 0x4000
LW_62:
    ds_read_b32 v9, v10
    s_waitcnt lgkmcnt(0)
    v_cmp_gt_u32 vcc, 1, v9
    s_cbranch_vccz LW_62_D
    s_sub_u32 s59, s59, 1
    s_cmp_lg_u32 s59, 0
    s_cbranch_scc1 LW_62
LW_62_D:
AX_NH:
    buffer_load_dwordx4 v16, s[36:39], s58 offen lds
    s_add_u32 m0, s41, 66560
    s_add_u32 s58, s40, 1024
    buffer_load_dwordx4 v12, s[32:35], s58 offen lds
    s_add_u32 m0, s41, 67584
    s_nop 0
    buffer_load_dwordx4 v13, s[32:35], s58 offen lds
    s_add_u32 m0, s41, 74752
    s_add_u32 s58, s40, 197632
    buffer_load_dwordx4 v12, s[32:35], s58 offen lds
    s_add_u32 m0, s41, 75776
    s_nop 0
    buffer_load_dwordx4 v13, s[32:35], s58 offen lds
    s_add_u32 m0, s41, 82944
    s_add_u32 s58, s40, 394240
    buffer_load_dwordx4 v12, s[32:35], s58 offen lds
    s_add_u32 m0, s41, 83968
    s_nop 0
    buffer_load_dwordx4 v13, s[32:35], s58 offen lds
    s_add_u32 m0, s41, 91136
    s_add_u32 s58, s40, 590848
    buffer_load_dwordx4 v12, s[32:35], s58 offen lds
    s_add_u32 m0, s41, 92160
    s_nop 0
    buffer_load_dwordx4 v13, s[32:35], s58 offen lds
    s_add_u32 m0, s41, 99328
    s_add_u32 s58, s40, 787456
    buffer_load_dwordx4 v12, s[32:35], s58 offen lds
    s_add_u32 m0, s41, 100352
    s_nop 0
    buffer_load_dwordx4 v13, s[32:35], s58 offen lds
    s_add_u32 m0, s41, 107520
    s_add_u32 s58, s40, 984064
    buffer_load_dwordx4 v12, s[32:35], s58 offen lds
    s_add_u32 m0, s41, 108544
    s_nop 0
    buffer_load_dwordx4 v13, s[32:35], s58 offen lds
    s_waitcnt vmcnt(8)
    v_mov_b32 v9, 2
    ds_write_b32 v8, v9
    s_waitcnt vmcnt(4)
    v_mov_b32 v9, 4
    ds_write_b32 v8, v9
    s_waitcnt vmcnt(0)
    v_mov_b32 v9, 6
    ds_write_b32 v8, v9
    s_setprio 3
    v_mov_b32 v10, 163376
    s_mov_b32 s59, 0x4000
LW_63:
    ds_read_b32 v9, v10
    s_waitcnt lgkmcnt(0)
    v_cmp_gt_u32 vcc, 2, v9
    s_cbranch_vccz LW_63_D
    s_sub_u32 s59, s59, 1
    s_cmp_lg_u32 s59, 0
    s_cbranch_scc1 LW_63
LW_63_D:
    s_add_u32 m0, s41, 115712
    s_add_u32 s58, s40, 1180672
    buffer_load_dwordx4 v12, s[32:35], s58 offen lds
    s_add_u32 m0, s41, 116736
    s_nop 0
    buffer_load_dwordx4 v13, s[32:35], s58 offen lds
    s_add_u32 m0, s41, 123904
    s_add_u32 s58, s40, 1377280
    buffer_load_dwordx4 v12, s[32:35], s58 offen lds
    s_add_u32 m0, s41, 124928
    s_nop 0
    buffer_load_dwordx4 v13, s[32:35], s58 offen lds
    s_add_u32 m0, s41, 132096
    s_add_u32 s58, s40, 2048
    buffer_load_dwordx4 v12, s[32:35], s58 offen lds
    s_add_u32 m0, s41, 133120
    s_nop 0
    buffer_load_dwordx4 v13, s[32:35], s58 offen lds
    s_add_u32 m0, s41, 140288
    s_add_u32 s58, s40, 198656
    buffer_load_dwordx4 v12, s[32:35], s58 offen lds
    s_add_u32 m0, s41, 141312
    s_nop 0
    buffer_load_dwordx4 v13, s[32:35], s58 offen lds
    s_waitcnt vmcnt(6)
    v_mov_b32 v9, 7
    ds_write_b32 v8, v9
    s_waitcnt vmcnt(4)
    v_mov_b32 v9, 8
    ds_write_b32 v8, v9
    s_waitcnt vmcnt(2)
    v_mov_b32 v9, 9
    ds_write_b32 v8, v9
    ds_read_b32 v9, v7
    s_waitcnt lgkmcnt(0)
    v_cmp_gt_u32 vcc, 6, v9
    s_cbranch_vccz IT_64
    s_waitcnt vmcnt(0)
    v_mov_b32 v9, 10
    ds_write_b32 v8, v9
    s_mov_b32 s59, 0x4000
LW_65:
    ds_read_b32 v9, v7
    s_waitcnt lgkmcnt(0)
    v_cmp_gt_u32 vcc, 6, v9
    s_cbranch_vccz LW_65_D
    s_sub_u32 s59, s59, 1
    s_cmp_lg_u32 s59, 0
    s_cbranch_scc1 LW_65
LW_65_D:
IT_64:
    s_add_u32 m0, s41, 148480
    s_add_u32 s58, s40, 395264
    buffer_load_dwordx4 v12, s[32:35], s58 offen lds
    s_add_u32 m0, s41, 149504
    s_nop 0
    buffer_load_dwordx4 v13, s[32:35], s58 offen lds
    s_waitcnt vmcnt(2)
    v_mov_b32 v9, 10
    ds_write_b32 v8, v9
    ds_read_b32 v9, v5
    s_waitcnt lgkmcnt(0)
    v_cmp_gt_u32 vcc, 8, v9
    s_cbranch_vccz IT_66
    s_waitcnt vmcnt(0)
    v_mov_b32 v9, 11
    ds_write_b32 v8, v9
    s_mov_b32 s59, 0x4000
LW_67:
    ds_read_b32 v9, v5
    s_waitcnt lgkmcnt(0)
    v_cmp_gt_u32 vcc, 8, v9
    s_cbranch_vccz LW_67_D
    s_sub_u32 s59, s59, 1
    s_cmp_lg_u32 s59, 0
    s_cbranch_scc1 LW_67
LW_67_D:
IT_66:
    s_add_u32 m0, s41, 66560
    s_add_u32 s58, s40, 591872
    buffer_load_dwordx4 v12, s[32:35], s58 offen lds
    s_add_u32 m0, s41, 67584
    s_nop 0
    buffer_load_dwordx4 v13, s[32:35], s58 offen lds
    s_add_u32 m0, s41, 74752
    s_add_u32 s58, s40, 788480
    buffer_load_dwordx4 v12, s[32:35], s58 offen lds
    s_add_u32 m0, s41, 75776
    s_nop 0
    buffer_load_dwordx4 v13, s[32:35], s58 offen lds
    s_waitcnt vmcnt(4)
    v_mov_b32 v9, 11
    ds_write_b32 v8, v9
    ds_read_b32 v9, v5
    s_waitcnt lgkmcnt(0)
    v_cmp_gt_u32 vcc, 10, v9
    s_cbranch_vccz IT_68
    s_waitcnt vmcnt(0)
    v_mov_b32 v9, 13
    ds_write_b32 v8, v9
    s_mov_b32 s59, 0x4000
LW_69:
    ds_read_b32 v9, v5
    s_waitcnt lgkmcnt(0)
    v_cmp_gt_u32 vcc, 10, v9
    s_cbranch_vccz LW_69_D
    s_sub_u32 s59, s59, 1
    s_cmp_lg_u32 s59, 0
    s_cbranch_scc1 LW_69
LW_69_D:
IT_68:
    s_add_u32 m0, s41, 82944
    s_add_u32 s58, s40, 985088
    buffer_load_dwordx4 v12, s[32:35], s58 offen lds
    s_add_u32 m0, s41, 83968
    s_nop 0
    buffer_load_dwordx4 v13, s[32:35], s58 offen lds
    s_add_u32 m0, s41, 91136
    s_add_u32 s58, s40, 1181696
    buffer_load_dwordx4 v12, s[32:35], s58 offen lds
    s_add_u32 m0, s41, 92160
    s_nop 0
    buffer_load_dwordx4 v13, s[32:35], s58 offen lds
    s_waitcnt vmcnt(4)
    v_mov_b32 v9, 13
    ds_write_b32 v8, v9
    ds_read_b32 v9, v5
    s_waitcnt lgkmcnt(0)
    v_cmp_gt_u32 vcc, 12, v9
    s_cbranch_vccz IT_70
    s_waitcnt vmcnt(0)
    v_mov_b32 v9, 15
    ds_write_b32 v8, v9
    s_mov_b32 s59, 0x4000
LW_71:
    ds_read_b32 v9, v5
    s_waitcnt lgkmcnt(0)
    v_cmp_gt_u32 vcc, 12, v9
    s_cbranch_vccz LW_71_D
    s_sub_u32 s59, s59, 1
    s_cmp_lg_u32 s59, 0
    s_cbranch_scc1 LW_71
LW_71_D:
IT_70:
    s_add_u32 m0, s41, 99328
    s_add_u32 s58, s40, 1378304
    buffer_load_dwordx4 v12, s[32:35], s58 offen lds
    s_add_u32 m0, s41, 100352
    s_nop 0
    buffer_load_dwordx4 v13, s[32:35], s58 offen lds
    s_add_u32 m0, s41, 107520
    s_add_u32 s58, s40, 0
    buffer_load_dwordx4 v12, s[32:35], s58 offen lds
    s_add_u32 m0, s41, 108544
    s_nop 0
    buffer_load_dwordx4 v13, s[32:35], s58 offen lds
    s_waitcnt vmcnt(4)
    v_mov_b32 v9, 15
    ds_write_b32 v8, v9
    ds_read_b32 v9, v5
    s_waitcnt lgkmcnt(0)
    v_cmp_gt_u32 vcc, 14, v9
    s_cbranch_vccz IT_72
    s_waitcnt vmcnt(0)
    v_mov_b32 v9, 17
    ds_write_b32 v8, v9
    s_mov_b32 s59, 0x4000
LW_73:
    ds_read_b32 v9, v5
    s_waitcnt lgkmcnt(0)
    v_cmp_gt_u32 vcc, 14, v9
    s_cbranch_vccz LW_73_D
    s_sub_u32 s59, s59, 1
    s_cmp_lg_u32 s59, 0
    s_cbranch_scc1 LW_73
LW_73_D:
IT_72:
    s_add_u32 m0, s41, 115712
    s_add_u32 s58, s40, 196608
    buffer_load_dwordx4 v12, s[32:35], s58 offen lds
    s_add_u32 m0, s41, 116736
    s_nop 0
    buffer_load_dwordx4 v13, s[32:35], s58 offen lds
    s_add_u32 m0, s41, 123904
    s_add_u32 s58, s40, 393216
    buffer_load_dwordx4 v12, s[32:35], s58 offen lds
    s_add_u32 m0, s41, 124928
    s_nop 0
    buffer_load_dwordx4 v13, s[32:35], s58 offen lds
    s_waitcnt vmcnt(4)
    v_mov_b32 v9, 17
    ds_write_b32 v8, v9
    ds_read_b32 v9, v6
    s_waitcnt lgkmcnt(0)
    v_cmp_gt_u32 vcc, 8, v9
    s_cbranch_vccz IT_74
    s_waitcnt vmcnt(0)
    v_mov_b32 v9, 19
    ds_write_b32 v8, v9
    s_mov_b32 s59, 0x4000
LW_75:
    ds_read_b32 v9, v6
    s_waitcnt lgkmcnt(0)
    v_cmp_gt_u32 vcc, 8, v9
    s_cbranch_vccz LW_75_D
    s_sub_u32 s59, s59, 1
    s_cmp_lg_u32 s59, 0
    s_cbranch_scc1 LW_75
LW_75_D:
IT_74:
    s_add_u32 m0, s41, 132096
    s_add_u32 s58, s40, 589824
    buffer_load_dwordx4 v12, s[32:35], s58 offen lds
    s_add_u32 m0, s41, 133120
    s_nop 0
    buffer_load_dwordx4 v13, s[32:35], s58 offen lds
    s_add_u32 m0, s41, 140288
    s_add_u32 s58, s40, 786432
    buffer_load_dwordx4 v12, s[32:35], s58 offen lds
    s_add_u32 m0, s41, 141312
    s_nop 0
    buffer_load_dwordx4 v13, s[32:35], s58 offen lds
    s_waitcnt vmcnt(4)
    v_mov_b32 v9, 19
    ds_write_b32 v8, v9
    ds_read_b32 v9, v6
    s_waitcnt lgkmcnt(0)
    v_cmp_gt_u32 vcc, 10, v9
    s_cbranch_vccz IT_76
    s_waitcnt vmcnt(0)
    v_mov_b32 v9, 21
    ds_write_b32 v8, v9
    s_mov_b32 s59, 0x4000
LW_77:
    ds_read_b32 v9, v6
    s_waitcnt lgkmcnt(0)
    v_cmp_gt_u32 vcc, 10, v9
    s_cbranch_vccz LW_77_D
    s_sub_u32 s59, s59, 1
    s_cmp_lg_u32 s59, 0
    s_cbranch_scc1 LW_77
LW_77_D:
IT_76:
    s_add_u32 m0, s41, 148480
    s_add_u32 s58, s40, 983040
    buffer_load_dwordx4 v12, s[32:35], s58 offen lds
    s_add_u32 m0, s41, 149504
    s_nop 0
    buffer_load_dwordx4 v13, s[32:35], s58 offen lds
    s_add_u32 m0, s41, 66560
    s_add_u32 s58, s40, 1179648
    buffer_load_dwordx4 v12, s[32:35], s58 offen lds
    s_add_u32 m0, s41, 67584
    s_nop 0
    buffer_load_dwordx4 v13, s[32:35], s58 offen lds
    s_waitcnt vmcnt(4)
    v_mov_b32 v9, 21
    ds_write_b32 v8, v9
    ds_read_b32 v9, v6
    s_waitcnt lgkmcnt(0)
    v_cmp_gt_u32 vcc, 11, v9
    s_cbranch_vccz IT_78
    s_waitcnt vmcnt(0)
    v_mov_b32 v9, 23
    ds_write_b32 v8, v9
    s_mov_b32 s59, 0x4000
LW_79:
    ds_read_b32 v9, v6
    s_waitcnt lgkmcnt(0)
    v_cmp_gt_u32 vcc, 11, v9
    s_cbranch_vccz LW_79_D
    s_sub_u32 s59, s59, 1
    s_cmp_lg_u32 s59, 0
    s_cbranch_scc1 LW_79
LW_79_D:
IT_78:
    s_add_u32 m0, s41, 74752
    s_add_u32 s58, s40, 1376256
    buffer_load_dwordx4 v12, s[32:35], s58 offen lds
    s_add_u32 m0, s41, 75776
    s_nop 0
    buffer_load_dwordx4 v13, s[32:35], s58 offen lds
    s_waitcnt vmcnt(2)
    v_mov_b32 v9, 23
    ds_write_b32 v8, v9
    s_waitcnt vmcnt(0)
    v_mov_b32 v9, 24
    ds_write_b32 v8, v9
    s_mov_b32 s32, s10
    s_mov_b32 s33, s11
    s_mov_b32 s34, 0x80000
    s_mov_b32 s35, 0x00020000
    s_lshl_b32 s42, s56, 14
    s_lshl_b32 s58, s55, 7
    s_add_u32 s42, s42, s58
    s_mov_b32 s36, s14
    s_mov_b32 s37, s15
    s_mov_b32 s38, 0x158000
    s_mov_b32 s39, 0x00020000
    v_lshrrev_b32 v16, 3, v1
    v_mul_u32_u24 v16, 2752, v16
    v_and_b32 v20, 127, v14
    v_add_u32 v20, v20, v16
    s_cmp_ge_u32 s56, 2
    s_cselect_b32 s36, s16, s36
    s_cselect_b32 s37, s17, s37
    s_cselect_b32 s43, 6272, 0
    s_lshr_b32 s40, s2, 3
    s_lshr_b32 s58, s2, 5
    s_lshl_b32 s58, 1, s58
    s_and_b32 s58, s58, 136
    s_cselect_b32 s58, 16, 0
    s_xor_b32 s40, s40, s58
    s_mul_i32 s40, s40, 96
    s_andn2_b32 s40, s40, 63
    s_and_b32 s58, s56, 1
    s_lshl_b32 s59, s58, 12
    s_add_u32 s43, s43, s59
    s_mul_i32 s58, s58, 88064
    s_add_u32 s40, s40, s58
    s_and_b32 s58, s56, 1
    s_mul_i32 s58, s58, 192
    v_add_u32 v16, 0, v1
    v_add_u32 v16, s58, v16
    v_mul_u32_u24 v17, 43691, v16
    v_lshrrev_b32 v17, 18, v17
    v_mul_u32_u24 v18, 6, v17
    v_sub_u32 v18, v16, v18
    v_mul_u32_u24 v17, 2752, v17
    v_lshl_add_u32 v104, v18, 4, v17
    v_add_u32 v16, 64, v1
    v_add_u32 v16, s58, v16
    v_mul_u32_u24 v17, 43691, v16
    v_lshrrev_b32 v17, 18, v17
    v_mul_u32_u24 v18, 6, v17
    v_sub_u32 v18, v16, v18
    v_mul_u32_u24 v17, 2752, v17
    v_lshl_add_u32 v105, v18, 4, v17
    v_add_u32 v16, 128, v1
    v_add_u32 v16, s58, v16
    v_mul_u32_u24 v17, 43691, v16
    v_lshrrev_b32 v17, 18, v17
    v_mul_u32_u24 v18, 6, v17
    v_sub_u32 v18, v16, v18
    v_mul_u32_u24 v17, 2752, v17
    v_lshl_add_u32 v106, v18, 4, v17
    s_cmp_ge_u32 s56, 2
    s_cselect_b32 s43, 6272, 0
    s_lshr_b32 s40, s2, 3
    s_lshr_b32 s58, s2, 5
    s_lshl_b32 s58, 1, s58
    s_and_b32 s58, s58, 136
    s_cselect_b32 s58, 16, 0
    s_xor_b32 s40, s40, s58
    s_cmp_ge_u32 s40, 29
    s_cselect_b32 s38, 0, s38
    s_mul_i32 s40, s40, 96
    s_and_b32 s58, s56, 1
    s_mul_i32 s58, s58, 3072
    s_add_u32 s43, s43, s58
    s_mov_b32 s59, 0x4000
LW_80:
    ds_read_b32 v9, v6
    s_waitcnt lgkmcnt(0)
    v_cmp_gt_u32 vcc, 16, v9
    s_cbranch_vccz LW_80_D
    s_sub_u32 s59, s59, 1
    s_cmp_lg_u32 s59, 0
    s_cbranch_scc1 LW_80
LW_80_D:
    v_mov_b32 v10, 163376
    s_mov_b32 s59, 0x4000
LW_81:
    ds_read_b32 v9, v10
    s_waitcnt lgkmcnt(0)
    v_cmp_gt_u32 vcc, 4, v9
    s_cbranch_vccz LW_81_D
    s_sub_u32 s59, s59, 1
    s_cmp_lg_u32 s59, 0
    s_cbranch_scc1 LW_81
LW_81_D:
    s_add_u32 m0, s41, 91136
    s_add_u32 s58, s42, 0
    buffer_load_dwordx4 v14, s[32:35], s58 offen lds
    s_add_u32 m0, s41, 92160
    s_add_u32 s58, s58, 8192
    buffer_load_dwordx4 v14, s[32:35], s58 offen lds
    s_add_u32 m0, s41, 99328
    s_add_u32 s58, s42, 65536
    buffer_load_dwordx4 v14, s[32:35], s58 offen lds
    s_add_u32 m0, s41, 100352
    s_add_u32 s58, s58, 8192
    buffer_load_dwordx4 v14, s[32:35], s58 offen lds
    s_add_u32 m0, s41, 107520
    s_add_u32 s58, s42, 131072
    buffer_load_dwordx4 v14, s[32:35], s58 offen lds
    s_add_u32 m0, s41, 108544
    s_add_u32 s58, s58, 8192
    buffer_load_dwordx4 v14, s[32:35], s58 offen lds
    s_add_u32 m0, s41, 115712
    s_add_u32 s58, s42, 196608
    buffer_load_dwordx4 v14, s[32:35], s58 offen lds
    s_add_u32 m0, s41, 116736
    s_add_u32 s58, s58, 8192
    buffer_load_dwordx4 v14, s[32:35], s58 offen lds
    s_add_u32 m0, s41, 123904
    s_add_u32 s58, s42, 262144
    buffer_load_dwordx4 v14, s[32:35], s58 offen lds
    s_add_u32 m0, s41, 124928
    s_add_u32 s58, s58, 8192
    buffer_load_dwordx4 v14, s[32:35], s58 offen lds
    s_add_u32 m0, s41, 132096
    s_add_u32 s58, s42, 327680
    buffer_load_dwordx4 v14, s[32:35], s58 offen lds
    s_add_u32 m0, s41, 133120
    s_add_u32 s58, s58, 8192
    buffer_load_dwordx4 v14, s[32:35], s58 offen lds
    s_add_u32 m0, s41, 140288
    s_add_u32 s58, s42, 393216
    buffer_load_dwordx4 v14, s[32:35], s58 offen lds
    s_add_u32 m0, s41, 141312
    s_add_u32 s58, s58, 8192
    buffer_load_dwordx4 v14, s[32:35], s58 offen lds
    s_add_u32 m0, s41, 148480
    s_add_u32 s58, s42, 458752
    buffer_load_dwordx4 v14, s[32:35], s58 offen lds
    s_add_u32 m0, s41, 149504
    s_add_u32 s58, s58, 8192
    buffer_load_dwordx4 v14, s[32:35], s58 offen lds
    s_waitcnt vmcnt(4)
    s_waitcnt vmcnt(0)
    v_mov_b32 v9, 26
    ds_write_b32 v8, v9
    v_lshrrev_b32 v3, 5, v1
    v_bfe_u32 v19, v1, 4, 1
    v_bfe_u32 v16, v1, 2, 2
    v_lshl_add_u32 v16, v3, 2, v16
    v_mul_u32_u24 v16, 96, v16
    v_mul_u32_u24 v19, 6272, v19
    v_add_u32 v16, v16, v19
    v_and_b32 v19, 3, v1
    v_lshl_add_u32 v16, v19, 3, v16
    v_add_u32 v17, 32, v16
    v_add_u32 v18, 64, v16
    s_mul_i32 s58, s56, 1536
    v_add_u32 v16, s58, v16
    v_add_u32 v21, 50176, v16
    v_add_u32 v17, s58, v17
    v_add_u32 v22, 50176, v17
    v_add_u32 v18, s58, v18
    v_add_u32 v23, 50176, v18
    v_lshlrev_b32 v19, 4, v3
    s_lshl_b32 s58, s56, 6
    s_add_u32 s58, s58, 156672
    v_add_u32 v19, s58, v19
    v_mov_b32 v24, 0
    v_mov_b32 v25, 0
    v_mov_b32 v26, 0
    v_mov_b32 v27, 0
    v_mov_b32 v28, 0
    v_mov_b32 v29, 0
    v_mov_b32 v10, 163376
    s_mov_b32 s59, 0x4000
LW_82:
    ds_read_b32 v9, v10
    s_waitcnt lgkmcnt(0)
    v_cmp_gt_u32 vcc, 6, v9
    s_cbranch_vccz LW_82_D
    s_sub_u32 s59, s59, 1
    s_cmp_lg_u32 s59, 0
    s_cbranch_scc1 LW_82
LW_82_D:
    s_add_u32 s58, s40, 0
    s_add_u32 m0, s43, 0
    s_nop 0
    buffer_load_dwordx4 v104, s[36:39], s58 offen lds
    s_add_u32 m0, s43, 1024
    s_nop 0
    buffer_load_dwordx4 v105, s[36:39], s58 offen lds
    s_add_u32 m0, s43, 2048
    s_nop 0
    buffer_load_dwordx4 v106, s[36:39], s58 offen lds
    s_add_u32 s58, s40, 176128
    s_add_u32 m0, s43, 12544
    s_nop 0
    buffer_load_dwordx4 v104, s[36:39], s58 offen lds
    s_add_u32 m0, s43, 13568
    s_nop 0
    buffer_load_dwordx4 v105, s[36:39], s58 offen lds
    s_add_u32 m0, s43, 14592
    s_nop 0
    buffer_load_dwordx4 v106, s[36:39], s58 offen lds
    s_add_u32 s58, s40, 352256
    s_add_u32 m0, s43, 25088
    s_nop 0
    buffer_load_dwordx4 v104, s[36:39], s58 offen lds
    s_add_u32 m0, s43, 26112
    s_nop 0
    buffer_load_dwordx4 v105, s[36:39], s58 offen lds
    s_add_u32 m0, s43, 27136
    s_nop 0
    buffer_load_dwordx4 v106, s[36:39], s58 offen lds
    s_add_u32 s58, s40, 528384
    s_add_u32 m0, s43, 37632
    s_nop 0
    buffer_load_dwordx4 v104, s[36:39], s58 offen lds
    s_add_u32 m0, s43, 38656
    s_nop 0
    buffer_load_dwordx4 v105, s[36:39], s58 offen lds
    s_add_u32 m0, s43, 39680
    s_nop 0
    buffer_load_dwordx4 v106, s[36:39], s58 offen lds
    s_waitcnt vmcnt(0)
    v_mov_b32 v9, 30
    ds_write_b32 v8, v9
    s_mov_b32 s59, 0x4000
LW_83:
    ds_read_b32 v9, v7
    s_waitcnt lgkmcnt(0)
    v_cmp_gt_u32 vcc, 20, v9
    s_cbranch_vccz LW_83_D
    s_sub_u32 s59, s59, 1
    s_cmp_lg_u32 s59, 0
    s_cbranch_scc1 LW_83
LW_83_D:
    s_add_u32 s58, s40, 704512
    s_add_u32 m0, s43, 50176
    s_nop 0
    buffer_load_dwordx4 v104, s[36:39], s58 offen lds
    s_add_u32 m0, s43, 51200
    s_nop 0
    buffer_load_dwordx4 v105, s[36:39], s58 offen lds
    s_add_u32 m0, s43, 52224
    s_nop 0
    buffer_load_dwordx4 v106, s[36:39], s58 offen lds
    s_add_u32 s58, s40, 880640
    s_add_u32 m0, s43, 62720
    s_nop 0
    buffer_load_dwordx4 v104, s[36:39], s58 offen lds
    s_add_u32 m0, s43, 63744
    s_nop 0
    buffer_load_dwordx4 v105, s[36:39], s58 offen lds
    s_add_u32 m0, s43, 64768
    s_nop 0
    buffer_load_dwordx4 v106, s[36:39], s58 offen lds
    s_add_u32 s58, s40, 1056768
    s_add_u32 m0, s43, 75264
    s_nop 0
    buffer_load_dwordx4 v104, s[36:39], s58 offen lds
    s_add_u32 m0, s43, 76288
    s_nop 0
    buffer_load_dwordx4 v105, s[36:39], s58 offen lds
    s_add_u32 m0, s43, 77312
    s_nop 0
    buffer_load_dwordx4 v106, s[36:39], s58 offen lds
    s_mov_b32 s59, 0x4000
LW_84:
    ds_read_b32 v9, v15
    s_waitcnt lgkmcnt(0)
    v_cmp_gt_u32 vcc, 30, v9
    s_cbranch_vccz LW_84_D
    s_sub_u32 s59, s59, 1
    s_cmp_lg_u32 s59, 0
    s_cbranch_scc1 LW_84
LW_84_D:
    v_mov_b32 v10, 163376
    s_mov_b32 s59, 0x4000
LW_85:
    ds_read_b32 v9, v10
    s_waitcnt lgkmcnt(0)
    v_cmp_gt_u32 vcc, 9, v9
    s_cbranch_vccz LW_85_D
    s_sub_u32 s59, s59, 1
    s_cmp_lg_u32 s59, 0
    s_cbranch_scc1 LW_85
LW_85_D:
    ds_read_b128 v[36:39], v19 offset:0
    ds_read_b128 v[40:43], v19 offset:32
    ds_read_b64_tr_b16 v[44:45], v16 offset:0
    ds_read_b64_tr_b16 v[46:47], v16 offset:768
    ds_read_b64_tr_b16 v[48:49], v17 offset:0
    ds_read_b64_tr_b16 v[50:51], v17 offset:768
    ds_read_b64_tr_b16 v[52:53], v18 offset:0
    ds_read_b64_tr_b16 v[54:55], v18 offset:768
    s_waitcnt lgkmcnt(0)
    v_dot2_f32_bf16 v24, v44, v36, v24
    v_dot2_f32_bf16 v25, v44, v40, v25
    v_dot2_f32_bf16 v26, v48, v36, v26
    v_dot2_f32_bf16 v27, v48, v40, v27
    v_dot2_f32_bf16 v28, v52, v36, v28
    v_dot2_f32_bf16 v29, v52, v40, v29
    v_dot2_f32_bf16 v24, v45, v37, v24
    v_dot2_f32_bf16 v25, v45, v41, v25
    v_dot2_f32_bf16 v26, v49, v37, v26
    v_dot2_f32_bf16 v27, v49, v41, v27
    v_dot2_f32_bf16 v28, v53, v37, v28
    v_dot2_f32_bf16 v29, v53, v41, v29
    v_dot2_f32_bf16 v24, v46, v38, v24
    v_dot2_f32_bf16 v25, v46, v42, v25
    v_dot2_f32_bf16 v26, v50, v38, v26
    v_dot2_f32_bf16 v27, v50, v42, v27
    v_dot2_f32_bf16 v28, v54, v38, v28
    v_dot2_f32_bf16 v29, v54, v42, v29
    v_dot2_f32_bf16 v24, v47, v39, v24
    v_dot2_f32_bf16 v25, v47, v43, v25
    v_dot2_f32_bf16 v26, v51, v39, v26
    v_dot2_f32_bf16 v27, v51, v43, v27
    v_dot2_f32_bf16 v28, v55, v39, v28
    v_dot2_f32_bf16 v29, v55, v43, v29
    ds_read_b128 v[36:39], v19 offset:256
    ds_read_b128 v[40:43], v19 offset:288
    ds_read_b64_tr_b16 v[44:45], v16 offset:12544
    ds_read_b64_tr_b16 v[46:47], v16 offset:13312
    ds_read_b64_tr_b16 v[48:49], v17 offset:12544
    ds_read_b64_tr_b16 v[50:51], v17 offset:13312
    ds_read_b64_tr_b16 v[52:53], v18 offset:12544
    ds_read_b64_tr_b16 v[54:55], v18 offset:13312
    s_waitcnt lgkmcnt(0)
    v_dot2_f32_bf16 v24, v44, v36, v24
    v_dot2_f32_bf16 v25, v44, v40, v25
    v_dot2_f32_bf16 v26, v48, v36, v26
    v_dot2_f32_bf16 v27, v48, v40, v27
    v_dot2_f32_bf16 v28, v52, v36, v28
    v_dot2_f32_bf16 v29, v52, v40, v29
    v_dot2_f32_bf16 v24, v45, v37, v24
    v_dot2_f32_bf16 v25, v45, v41, v25
    v_dot2_f32_bf16 v26, v49, v37, v26
    v_dot2_f32_bf16 v27, v49, v41, v27
    v_dot2_f32_bf16 v28, v53, v37, v28
    v_dot2_f32_bf16 v29, v53, v41, v29
    v_dot2_f32_bf16 v24, v46, v38, v24
    v_dot2_f32_bf16 v25, v46, v42, v25
    v_dot2_f32_bf16 v26, v50, v38, v26
    v_dot2_f32_bf16 v27, v50, v42, v27
    v_dot2_f32_bf16 v28, v54, v38, v28
    v_dot2_f32_bf16 v29, v54, v42, v29
    v_dot2_f32_bf16 v24, v47, v39, v24
    v_dot2_f32_bf16 v25, v47, v43, v25
    v_dot2_f32_bf16 v26, v51, v39, v26
    v_dot2_f32_bf16 v27, v51, v43, v27
    v_dot2_f32_bf16 v28, v55, v39, v28
    v_dot2_f32_bf16 v29, v55, v43, v29
    ds_read_b128 v[36:39], v19 offset:512
    ds_read_b128 v[40:43], v19 offset:544
    ds_read_b64_tr_b16 v[44:45], v16 offset:25088
    ds_read_b64_tr_b16 v[46:47], v16 offset:25856
    ds_read_b64_tr_b16 v[48:49], v17 offset:25088
    ds_read_b64_tr_b16 v[50:51], v17 offset:25856
    ds_read_b64_tr_b16 v[52:53], v18 offset:25088
    ds_read_b64_tr_b16 v[54:55], v18 offset:25856
    s_waitcnt lgkmcnt(0)
    v_dot2_f32_bf16 v24, v44, v36, v24
    v_dot2_f32_bf16 v25, v44, v40, v25
    v_dot2_f32_bf16 v26, v48, v36, v26
    v_dot2_f32_bf16 v27, v48, v40, v27
    v_dot2_f32_bf16 v28, v52, v36, v28
    v_dot2_f32_bf16 v29, v52, v40, v29
    v_dot2_f32_bf16 v24, v45, v37, v24
    v_dot2_f32_bf16 v25, v45, v41, v25
    v_dot2_f32_bf16 v26, v49, v37, v26
    v_dot2_f32_bf16 v27, v49, v41, v27
    v_dot2_f32_bf16 v28, v53, v37, v28
    v_dot2_f32_bf16 v29, v53, v41, v29
    v_dot2_f32_bf16 v24, v46, v38, v24
    v_dot2_f32_bf16 v25, v46, v42, v25
    v_dot2_f32_bf16 v26, v50, v38, v26
    v_dot2_f32_bf16 v27, v50, v42, v27
    v_dot2_f32_bf16 v28, v54, v38, v28
    v_dot2_f32_bf16 v29, v54, v42, v29
    v_dot2_f32_bf16 v24, v47, v39, v24
    v_dot2_f32_bf16 v25, v47, v43, v25
    v_dot2_f32_bf16 v26, v51, v39, v26
    v_dot2_f32_bf16 v27, v51, v43, v27
    v_dot2_f32_bf16 v28, v55, v39, v28
    v_dot2_f32_bf16 v29, v55, v43, v29
    ds_read_b128 v[36:39], v19 offset:768
    ds_read_b128 v[40:43], v19 offset:800
    ds_read_b64_tr_b16 v[44:45], v16 offset:37632
    ds_read_b64_tr_b16 v[46:47], v16 offset:38400
    ds_read_b64_tr_b16 v[48:49], v17 offset:37632
    ds_read_b64_tr_b16 v[50:51], v17 offset:38400
    ds_read_b64_tr_b16 v[52:53], v18 offset:37632
    ds_read_b64_tr_b16 v[54:55], v18 offset:38400
    s_waitcnt lgkmcnt(0)
    v_dot2_f32_bf16 v24, v44, v36, v24
    v_dot2_f32_bf16 v25, v44, v40, v25
    v_dot2_f32_bf16 v26, v48, v36, v26
    v_dot2_f32_bf16 v27, v48, v40, v27
    v_dot2_f32_bf16 v28, v52, v36, v28
    v_dot2_f32_bf16 v29, v52, v40, v29
    v_dot2_f32_bf16 v24, v45, v37, v24
    v_dot2_f32_bf16 v25, v45, v41, v25
    v_dot2_f32_bf16 v26, v49, v37, v26
    v_dot2_f32_bf16 v27, v49, v41, v27
    v_dot2_f32_bf16 v28, v53, v37, v28
    v_dot2_f32_bf16 v29, v53, v41, v29
    v_dot2_f32_bf16 v24, v46, v38, v24
    v_dot2_f32_bf16 v25, v46, v42, v25
    v_dot2_f32_bf16 v26, v50, v38, v26
    v_dot2_f32_bf16 v27, v50, v42, v27
    v_dot2_f32_bf16 v28, v54, v38, v28
    v_dot2_f32_bf16 v29, v54, v42, v29
    v_dot2_f32_bf16 v24, v47, v39, v24
    v_dot2_f32_bf16 v25, v47, v43, v25
    v_dot2_f32_bf16 v26, v51, v39, v26
    v_dot2_f32_bf16 v27, v51, v43, v27
    v_dot2_f32_bf16 v28, v55, v39, v28
    v_dot2_f32_bf16 v29, v55, v43, v29
    s_waitcnt vmcnt(0)
    v_mov_b32 v9, 33
    ds_write_b32 v8, v9
    s_mov_b32 s59, 0x4000
LW_86:
    ds_read_b32 v9, v15
    s_waitcnt lgkmcnt(0)
    v_cmp_gt_u32 vcc, 33, v9
    s_cbranch_vccz LW_86_D
    s_sub_u32 s59, s59, 1
    s_cmp_lg_u32 s59, 0
    s_cbranch_scc1 LW_86
LW_86_D:
    ds_read_b128 v[36:39], v19 offset:1024
    ds_read_b128 v[40:43], v19 offset:1056
    ds_read_b64_tr_b16 v[44:45], v21 offset:0
    ds_read_b64_tr_b16 v[46:47], v21 offset:768
    ds_read_b64_tr_b16 v[48:49], v22 offset:0
    ds_read_b64_tr_b16 v[50:51], v22 offset:768
    ds_read_b64_tr_b16 v[52:53], v23 offset:0
    ds_read_b64_tr_b16 v[54:55], v23 offset:768
    s_waitcnt lgkmcnt(0)
    v_dot2_f32_bf16 v24, v44, v36, v24
    v_dot2_f32_bf16 v25, v44, v40, v25
    v_dot2_f32_bf16 v26, v48, v36, v26
    v_dot2_f32_bf16 v27, v48, v40, v27
    v_dot2_f32_bf16 v28, v52, v36, v28
    v_dot2_f32_bf16 v29, v52, v40, v29
    v_dot2_f32_bf16 v24, v45, v37, v24
    v_dot2_f32_bf16 v25, v45, v41, v25
    v_dot2_f32_bf16 v26, v49, v37, v26
    v_dot2_f32_bf16 v27, v49, v41, v27
    v_dot2_f32_bf16 v28, v53, v37, v28
    v_dot2_f32_bf16 v29, v53, v41, v29
    v_dot2_f32_bf16 v24, v46, v38, v24
    v_dot2_f32_bf16 v25, v46, v42, v25
    v_dot2_f32_bf16 v26, v50, v38, v26
    v_dot2_f32_bf16 v27, v50, v42, v27
    v_dot2_f32_bf16 v28, v54, v38, v28
    v_dot2_f32_bf16 v29, v54, v42, v29
    v_dot2_f32_bf16 v24, v47, v39, v24
    v_dot2_f32_bf16 v25, v47, v43, v25
    v_dot2_f32_bf16 v26, v51, v39, v26
    v_dot2_f32_bf16 v27, v51, v43, v27
    v_dot2_f32_bf16 v28, v55, v39, v28
    v_dot2_f32_bf16 v29, v55, v43, v29
    ds_read_b128 v[36:39], v19 offset:1280
    ds_read_b128 v[40:43], v19 offset:1312
    ds_read_b64_tr_b16 v[44:45], v21 offset:12544
    ds_read_b64_tr_b16 v[46:47], v21 offset:13312
    ds_read_b64_tr_b16 v[48:49], v22 offset:12544
    ds_read_b64_tr_b16 v[50:51], v22 offset:13312
    ds_read_b64_tr_b16 v[52:53], v23 offset:12544
    ds_read_b64_tr_b16 v[54:55], v23 offset:13312
    s_waitcnt lgkmcnt(0)
    v_dot2_f32_bf16 v24, v44, v36, v24
    v_dot2_f32_bf16 v25, v44, v40, v25
    v_dot2_f32_bf16 v26, v48, v36, v26
    v_dot2_f32_bf16 v27, v48, v40, v27
    v_dot2_f32_bf16 v28, v52, v36, v28
    v_dot2_f32_bf16 v29, v52, v40, v29
    v_dot2_f32_bf16 v24, v45, v37, v24
    v_dot2_f32_bf16 v25, v45, v41, v25
    v_dot2_f32_bf16 v26, v49, v37, v26
    v_dot2_f32_bf16 v27, v49, v41, v27
    v_dot2_f32_bf16 v28, v53, v37, v28
    v_dot2_f32_bf16 v29, v53, v41, v29
    v_dot2_f32_bf16 v24, v46, v38, v24
    v_dot2_f32_bf16 v25, v46, v42, v25
    v_dot2_f32_bf16 v26, v50, v38, v26
    v_dot2_f32_bf16 v27, v50, v42, v27
    v_dot2_f32_bf16 v28, v54, v38, v28
    v_dot2_f32_bf16 v29, v54, v42, v29
    v_dot2_f32_bf16 v24, v47, v39, v24
    v_dot2_f32_bf16 v25, v47, v43, v25
    v_dot2_f32_bf16 v26, v51, v39, v26
    v_dot2_f32_bf16 v27, v51, v43, v27
    v_dot2_f32_bf16 v28, v55, v39, v28
    v_dot2_f32_bf16 v29, v55, v43, v29
    ds_read_b128 v[36:39], v19 offset:1536
    ds_read_b128 v[40:43], v19 offset:1568
    ds_read_b64_tr_b16 v[44:45], v21 offset:25088
    ds_read_b64_tr_b16 v[46:47], v21 offset:25856
    ds_read_b64_tr_b16 v[48:49], v22 offset:25088
    ds_read_b64_tr_b16 v[50:51], v22 offset:25856
    ds_read_b64_tr_b16 v[52:53], v23 offset:25088
    ds_read_b64_tr_b16 v[54:55], v23 offset:25856
    s_waitcnt lgkmcnt(0)
    v_dot2_f32_bf16 v24, v44, v36, v24
    v_dot2_f32_bf16 v25, v44, v40, v25
    v_dot2_f32_bf16 v26, v48, v36, v26
    v_dot2_f32_bf16 v27, v48, v40, v27
    v_dot2_f32_bf16 v28, v52, v36, v28
    v_dot2_f32_bf16 v29, v52, v40, v29
    v_dot2_f32_bf16 v24, v45, v37, v24
    v_dot2_f32_bf16 v25, v45, v41, v25
    v_dot2_f32_bf16 v26, v49, v37, v26
    v_dot2_f32_bf16 v27, v49, v41, v27
    v_dot2_f32_bf16 v28, v53, v37, v28
    v_dot2_f32_bf16 v29, v53, v41, v29
    v_dot2_f32_bf16 v24, v46, v38, v24
    v_dot2_f32_bf16 v25, v46, v42, v25
    v_dot2_f32_bf16 v26, v50, v38, v26
    v_dot2_f32_bf16 v27, v50, v42, v27
    v_dot2_f32_bf16 v28, v54, v38, v28
    v_dot2_f32_bf16 v29, v54, v42, v29
    v_dot2_f32_bf16 v24, v47, v39, v24
    v_dot2_f32_bf16 v25, v47, v43, v25
    v_dot2_f32_bf16 v26, v51, v39, v26
    v_dot2_f32_bf16 v27, v51, v43, v27
    v_dot2_f32_bf16 v28, v55, v39, v28
    v_dot2_f32_bf16 v29, v55, v43, v29
    v_mov_b32 v10, 163376
    s_mov_b32 s59, 0x4000
LW_87:
    ds_read_b32 v9, v10
    s_waitcnt lgkmcnt(0)
    v_cmp_gt_u32 vcc, 10, v9
    s_cbranch_vccz LW_87_D
    s_sub_u32 s59, s59, 1
    s_cmp_lg_u32 s59, 0
    s_cbranch_scc1 LW_87
LW_87_D:
    s_add_u32 s58, s40, 1232896
    s_add_u32 m0, s43, 87808
    s_nop 0
    buffer_load_dwordx4 v104, s[36:39], s58 offen lds
    s_add_u32 m0, s43, 88832
    s_nop 0
    buffer_load_dwordx4 v105, s[36:39], s58 offen lds
    s_add_u32 m0, s43, 89856
    s_nop 0
    buffer_load_dwordx4 v106, s[36:39], s58 offen lds
    s_mov_b32 s44, s18
    s_mov_b32 s45, s19
    s_mov_b32 s46, 0x158000
    s_mov_b32 s47, 0x00020000
    s_lshl_b32 s40, s56, 13
    s_lshl_b32 s58, s55, 7
    s_add_u32 s40, s40, s58
    s_lshl_b32 s41, s56, 10
    s_and_b32 s42, s56, 1
    s_lshl_b32 s43, s42, 10
    s_lshl_b32 s42, s42, 13
    s_add_u32 s42, s42, s58
    s_add_u32 m0, s41, 100352
    s_add_u32 s58, s40, 868352
    buffer_load_dwordx4 v14, s[44:47], s58 offen lds
    s_add_u32 m0, s41, 104448
    s_add_u32 s58, s40, 901120
    buffer_load_dwordx4 v14, s[44:47], s58 offen lds
    s_add_u32 m0, s41, 108544
    s_add_u32 s58, s40, 933888
    buffer_load_dwordx4 v14, s[44:47], s58 offen lds
    s_add_u32 m0, s41, 112640
    s_add_u32 s58, s40, 966656
    buffer_load_dwordx4 v14, s[44:47], s58 offen lds
    s_add_u32 m0, s41, 116736
    s_add_u32 s58, s40, 999424
    buffer_load_dwordx4 v14, s[44:47], s58 offen lds
    s_add_u32 m0, s41, 120832
    s_add_u32 s58, s40, 1064960
    buffer_load_dwordx4 v14, s[44:47], s58 offen lds
    s_add_u32 m0, s41, 124928
    s_add_u32 s58, s40, 1097728
    buffer_load_dwordx4 v14, s[44:47], s58 offen lds
    s_add_u32 m0, s41, 129024
    s_add_u32 s58, s40, 1130496
    buffer_load_dwordx4 v14, s[44:47], s58 offen lds
    s_add_u32 m0, s41, 133120
    s_add_u32 s58, s40, 1163264
    buffer_load_dwordx4 v14, s[44:47], s58 offen lds
    s_add_u32 m0, s41, 137216
    s_add_u32 s58, s40, 1196032
    buffer_load_dwordx4 v14, s[44:47], s58 offen lds
    s_add_u32 m0, s41, 141312
    s_add_u32 s58, s40, 1228800
    buffer_load_dwordx4 v14, s[44:47], s58 offen lds
    s_add_u32 m0, s41, 145408
    s_add_u32 s58, s40, 1261568
    buffer_load_dwordx4 v14, s[44:47], s58 offen lds
    s_add_u32 m0, s41, 149504
    s_add_u32 s58, s40, 1294336
    buffer_load_dwordx4 v14, s[44:47], s58 offen lds
    v_lshlrev_b32 v13, 4, v1
    v_add_u32 v13, s41, v13
    s_waitcnt vmcnt(13)
    v_mov_b32 v9, 34
    ds_write_b32 v8, v9
    s_mov_b32 s59, 0x4000
LW_88:
    ds_read_b32 v9, v15
    s_waitcnt lgkmcnt(0)
    v_cmp_gt_u32 vcc, 34, v9
    s_cbranch_vccz LW_88_D
    s_sub_u32 s59, s59, 1
    s_cmp_lg_u32 s59, 0
    s_cbranch_scc1 LW_88
LW_88_D:
    ds_read_b128 v[36:39], v19 offset:1792
    ds_read_b128 v[40:43], v19 offset:1824
    ds_read_b64_tr_b16 v[44:45], v21 offset:37632
    ds_read_b64_tr_b16 v[46:47], v21 offset:38400
    ds_read_b64_tr_b16 v[48:49], v22 offset:37632
    ds_read_b64_tr_b16 v[50:51], v22 offset:38400
    ds_read_b64_tr_b16 v[52:53], v23 offset:37632
    ds_read_b64_tr_b16 v[54:55], v23 offset:38400
    s_waitcnt lgkmcnt(0)
    v_dot2_f32_bf16 v24, v44, v36, v24
    v_dot2_f32_bf16 v25, v44, v40, v25
    v_dot2_f32_bf16 v26, v48, v36, v26
    v_dot2_f32_bf16 v27, v48, v40, v27
    v_dot2_f32_bf16 v28, v52, v36, v28
    v_dot2_f32_bf16 v29, v52, v40, v29
    v_dot2_f32_bf16 v24, v45, v37, v24
    v_dot2_f32_bf16 v25, v45, v41, v25
    v_dot2_f32_bf16 v26, v49, v37, v26
    v_dot2_f32_bf16 v27, v49, v41, v27
    v_dot2_f32_bf16 v28, v53, v37, v28
    v_dot2_f32_bf16 v29, v53, v41, v29
    v_dot2_f32_bf16 v24, v46, v38, v24
    v_dot2_f32_bf16 v25, v46, v42, v25
    v_dot2_f32_bf16 v26, v50, v38, v26
    v_dot2_f32_bf16 v27, v50, v42, v27
    v_dot2_f32_bf16 v28, v54, v38, v28
    v_dot2_f32_bf16 v29, v54, v42, v29
    v_dot2_f32_bf16 v24, v47, v39, v24
    v_dot2_f32_bf16 v25, v47, v43, v25
    v_dot2_f32_bf16 v26, v51, v39, v26
    v_dot2_f32_bf16 v27, v51, v43, v27
    v_dot2_f32_bf16 v28, v55, v39, v28
    v_dot2_f32_bf16 v29, v55, v43, v29
    v_mov_b32 v44, v24
    v_mov_b32 v45, v25
    v_mov_b32 v46, v26
    v_mov_b32 v47, v27
    v_mov_b32 v48, v28
    v_mov_b32 v49, v29
    v_permlane32_swap_b32 v44, v24
    v_permlane32_swap_b32 v45, v25
    v_permlane32_swap_b32 v46, v26
    v_permlane32_swap_b32 v47, v27
    v_permlane32_swap_b32 v48, v28
    v_permlane32_swap_b32 v49, v29
    v_add_f32 v24, v24, v44
    v_add_f32 v25, v25, v45
    v_add_f32 v26, v26, v46
    v_add_f32 v27, v27, v47
    v_add_f32 v28, v28, v48
    v_add_f32 v29, v29, v49
    v_and_b32 v2, 31, v1
    v_lshlrev_b32 v4, 2, v2
    s_mul_i32 s58, s56, 768
    s_add_u32 s58, s58, 153600
    v_add_u32 v4, s58, v4
    ds_write_b32 v4, v24 offset:0
    ds_write_b32 v4, v25 offset:128
    ds_write_b32 v4, v26 offset:256
    ds_write_b32 v4, v27 offset:384
    ds_write_b32 v4, v28 offset:512
    ds_write_b32 v4, v29 offset:640
    v_mov_b32 v9, 35
    ds_write_b32 v8, v9
    s_mov_b32 s59, 0x4000
LW_89:
    ds_read_b32 v9, v15
    s_waitcnt lgkmcnt(0)
    v_cmp_gt_u32 vcc, 35, v9
    s_cbranch_vccz LW_89_D
    s_sub_u32 s59, s59, 1
    s_cmp_lg_u32 s59, 0
    s_cbranch_scc1 LW_89
LW_89_D:
    v_lshlrev_b32 v18, 2, v1
    s_mul_i32 s58, s56, 192
    s_add_u32 s59, s58, 159744
    v_add_u32 v4, s59, v18
    s_add_u32 s58, s58, 153600
    v_add_u32 v18, s58, v18
    ds_read_b32 v24, v18
    ds_read_b32 v25, v18 offset:768
    ds_read_b32 v26, v18 offset:1536
    ds_read_b32 v27, v18 offset:2304
    v_cmp_gt_u32 vcc, 48, v1
    s_waitcnt lgkmcnt(0)
    v_add_f32 v24, v24, v25
    v_add_f32 v26, v26, v27
    v_add_f32 v24, v24, v26
    s_and_saveexec_b64 s[60:61], vcc
    ds_write_b32 v4, v24
    s_mov_b64 exec, s[60:61]
    s_add_u32 s32, s28, 0x2800000
    s_addc_u32 s33, s29, 0
    s_mov_b32 s34, 0x20000
    s_mov_b32 s35, 0x00020000
    v_lshlrev_b32 v4, 4, v1
    s_and_b32 s60, s2, 7
    s_lshl_b32 s60, s60, 2
    s_add_u32 s60, s60, s56
    s_lshl_b32 s60, s60, 12
    v_and_b32 v18, 15, v1
    v_lshlrev_b32 v18, 4, v18
    v_bfe_u32 v24, v1, 4, 1
    v_lshl_add_u32 v18, v24, 3, v18
    v_lshl_add_u32 v18, v3, 8, v18
    s_lshl_b32 s58, s56, 9
    s_add_u32 s58, s58, 160512
    v_add_u32 v18, s58, v18
    s_setprio 3
    v_mov_b32 v10, 163376
    s_mov_b32 s59, 0x4000
LW_90:
    ds_read_b32 v9, v10
    s_waitcnt lgkmcnt(0)
    v_cmp_gt_u32 vcc, 11, v9
    s_cbranch_vccz LW_90_D
    s_sub_u32 s59, s59, 1
    s_cmp_lg_u32 s59, 0
    s_cbranch_scc1 LW_90
LW_90_D:
    buffer_load_dwordx4 v[36:39], v4, s[32:35], s60 offen offset:0 sc1
    buffer_load_dwordx4 v[44:47], v4, s[32:35], s60 offen offset:1024 sc1
    buffer_load_dwordx4 v[40:43], v4, s[32:35], s60 offen offset:2048 sc1
    buffer_load_dwordx4 v[48:51], v4, s[32:35], s60 offen offset:3072 sc1
    s_waitcnt vmcnt(0)
    v_pk_add_f32 v[36:37], v[36:37], v[44:45]
    v_pk_add_f32 v[38:39], v[38:39], v[46:47]
    v_pk_add_f32 v[40:41], v[40:41], v[48:49]
    v_pk_add_f32 v[42:43], v[42:43], v[50:51]
    s_nop 0
    v_permlane32_swap_b32 v36, v40
    v_permlane32_swap_b32 v37, v41
    v_permlane32_swap_b32 v38, v42
    v_permlane32_swap_b32 v39, v43
    v_pk_add_f32 v[36:37], v[36:37], v[40:41]
    v_pk_add_f32 v[38:39], v[38:39], v[42:43]
    s_nop 1
    v_permlane16_swap_b32 v36, v38
    v_permlane16_swap_b32 v37, v39
    v_pk_add_f32 v[100:101], v[36:37], v[38:39]
    v_mul_f32 v100, 0x3b000000, v100
    v_mul_f32 v101, 0x3b000000, v101
    v_fma_f32 v101, -v100, v100, v101
    v_max_f32 v101, 0, v101
    v_cvt_pk_bf16_f32 v100, v100, v100
    v_lshlrev_b32 v100, 16, v100
    v_cvt_pk_bf16_f32 v101, v101, v101
    v_lshlrev_b32 v101, 16, v101
    v_add_f32 v101, 0x3727c5ac, v101
    v_cvt_pk_bf16_f32 v101, v101, v101
    v_lshlrev_b32 v101, 16, v101
    v_sqrt_f32 v101, v101
    s_nop 0
    v_cvt_pk_bf16_f32 v101, v101, v101
    v_lshlrev_b32 v101, 16, v101
    v_rcp_f32 v102, v101
    v_sub_f32 v103, 0, v100
    ds_write_b64 v18, v[102:103]
    v_mov_b32 v9, 36
    ds_write_b32 v8, v9
    s_mov_b32 s59, 0x4000
LW_91:
    ds_read_b32 v9, v15
    s_waitcnt lgkmcnt(0)
    v_cmp_gt_u32 vcc, 36, v9
    s_cbranch_vccz LW_91_D
    s_sub_u32 s59, s59, 1
    s_cmp_lg_u32 s59, 0
    s_cbranch_scc1 LW_91
LW_91_D:
    s_mov_b32 s59, 0x4000
LW_92:
    ds_read_b32 v9, v7
    s_waitcnt lgkmcnt(0)
    v_cmp_gt_u32 vcc, 25, v9
    s_cbranch_vccz LW_92_D
    s_sub_u32 s59, s59, 1
    s_cmp_lg_u32 s59, 0
    s_cbranch_scc1 LW_92
LW_92_D:
    s_add_u32 m0, s41, 153600
    s_add_u32 s58, s40, 1327104
    buffer_load_dwordx4 v14, s[44:47], s58 offen lds
    s_add_u32 m0, s43, 157696
    s_add_u32 s58, s42, 1359872
    buffer_load_dwordx4 v14, s[44:47], s58 offen lds
    s_add_u32 m0, s41, 0
    s_add_u32 s58, s40, 0
    buffer_load_dwordx4 v14, s[44:47], s58 offen lds
    s_add_u32 m0, s41, 4096
    s_add_u32 s58, s40, 32768
    buffer_load_dwordx4 v14, s[44:47], s58 offen lds
    s_add_u32 m0, s41, 8192
    s_add_u32 s58, s40, 65536
    buffer_load_dwordx4 v14, s[44:47], s58 offen lds
    s_mov_b32 s59, 0x4000
LW_93:
    ds_read_b32 v9, v7
    s_waitcnt lgkmcnt(0)
    v_cmp_gt_u32 vcc, 26, v9
    s_cbranch_vccz LW_93_D
    s_sub_u32 s59, s59, 1
    s_cmp_lg_u32 s59, 0
    s_cbranch_scc1 LW_93
LW_93_D:
    s_add_u32 m0, s41, 12288
    s_add_u32 s58, s40, 98304
    buffer_load_dwordx4 v14, s[44:47], s58 offen lds
    s_add_u32 m0, s41, 16384
    s_add_u32 s58, s40, 131072
    buffer_load_dwordx4 v14, s[44:47], s58 offen lds
    s_add_u32 m0, s41, 20480
    s_add_u32 s58, s40, 163840
    buffer_load_dwordx4 v14, s[44:47], s58 offen lds
    s_mov_b32 s59, 0x4000
LW_94:
    ds_read_b32 v9, v7
    s_waitcnt lgkmcnt(0)
    v_cmp_gt_u32 vcc, 27, v9
    s_cbranch_vccz LW_94_D
    s_sub_u32 s59, s59, 1
    s_cmp_lg_u32 s59, 0
    s_cbranch_scc1 LW_94
LW_94_D:
    s_add_u32 m0, s41, 24576
    s_add_u32 s58, s40, 196608
    buffer_load_dwordx4 v14, s[44:47], s58 offen lds
    s_add_u32 m0, s41, 28672
    s_add_u32 s58, s40, 229376
    buffer_load_dwordx4 v14, s[44:47], s58 offen lds
    s_add_u32 m0, s41, 32768
    s_add_u32 s58, s40, 262144
    buffer_load_dwordx4 v14, s[44:47], s58 offen lds
    s_mov_b32 s59, 0x4000
LW_95:
    ds_read_b32 v9, v7
    s_waitcnt lgkmcnt(0)
    v_cmp_gt_u32 vcc, 28, v9
    s_cbranch_vccz LW_95_D
    s_sub_u32 s59, s59, 1
    s_cmp_lg_u32 s59, 0
    s_cbranch_scc1 LW_95
LW_95_D:
    s_add_u32 m0, s41, 36864
    s_add_u32 s58, s40, 294912
    buffer_load_dwordx4 v14, s[44:47], s58 offen lds
    s_add_u32 m0, s41, 40960
    s_add_u32 s58, s40, 360448
    buffer_load_dwordx4 v14, s[44:47], s58 offen lds
    s_add_u32 m0, s41, 45056
    s_add_u32 s58, s40, 393216
    buffer_load_dwordx4 v14, s[44:47], s58 offen lds
    s_mov_b32 s59, 0x4000
LW_96:
    ds_read_b32 v9, v7
    s_waitcnt lgkmcnt(0)
    v_cmp_gt_u32 vcc, 29, v9
    s_cbranch_vccz LW_96_D
    s_sub_u32 s59, s59, 1
    s_cmp_lg_u32 s59, 0
    s_cbranch_scc1 LW_96
LW_96_D:
    s_add_u32 m0, s41, 49152
    s_add_u32 s58, s40, 425984
    buffer_load_dwordx4 v14, s[44:47], s58 offen lds
    s_add_u32 m0, s41, 53248
    s_add_u32 s58, s40, 458752
    buffer_load_dwordx4 v14, s[44:47], s58 offen lds
    s_add_u32 m0, s41, 57344
    s_add_u32 s58, s40, 491520
    buffer_load_dwordx4 v14, s[44:47], s58 offen lds
    s_mov_b32 s59, 0x4000
LW_97:
    ds_read_b32 v9, v7
    s_waitcnt lgkmcnt(0)
    v_cmp_gt_u32 vcc, 30, v9
    s_cbranch_vccz LW_97_D
    s_sub_u32 s59, s59, 1
    s_cmp_lg_u32 s59, 0
    s_cbranch_scc1 LW_97
LW_97_D:
    s_add_u32 m0, s41, 61440
    s_add_u32 s58, s40, 524288
    buffer_load_dwordx4 v14, s[44:47], s58 offen lds
    s_add_u32 m0, s41, 65536
    s_add_u32 s58, s40, 557056
    buffer_load_dwordx4 v14, s[44:47], s58 offen lds
    s_add_u32 m0, s41, 69632
    s_add_u32 s58, s40, 589824
    buffer_load_dwordx4 v14, s[44:47], s58 offen lds
    s_mov_b32 s59, 0x4000
LW_98:
    ds_read_b32 v9, v7
    s_waitcnt lgkmcnt(0)
    v_cmp_gt_u32 vcc, 31, v9
    s_cbranch_vccz LW_98_D
    s_sub_u32 s59, s59, 1
    s_cmp_lg_u32 s59, 0
    s_cbranch_scc1 LW_98
LW_98_D:
    s_add_u32 m0, s41, 73728
    s_add_u32 s58, s40, 622592
    buffer_load_dwordx4 v14, s[44:47], s58 offen lds
    s_add_u32 m0, s41, 77824
    s_add_u32 s58, s40, 655360
    buffer_load_dwordx4 v14, s[44:47], s58 offen lds
    s_add_u32 m0, s41, 81920
    s_add_u32 s58, s40, 720896
    buffer_load_dwordx4 v14, s[44:47], s58 offen lds
    s_mov_b32 s59, 0x4000
LW_99:
    ds_read_b32 v9, v7
    s_waitcnt lgkmcnt(0)
    v_cmp_gt_u32 vcc, 32, v9
    s_cbranch_vccz LW_99_D
    s_sub_u32 s59, s59, 1
    s_cmp_lg_u32 s59, 0
    s_cbranch_scc1 LW_99
LW_99_D:
    s_add_u32 m0, s41, 86016
    s_add_u32 s58, s40, 753664
    buffer_load_dwordx4 v14, s[44:47], s58 offen lds
    s_add_u32 m0, s41, 90112
    s_add_u32 s58, s40, 786432
    buffer_load_dwordx4 v14, s[44:47], s58 offen lds
    s_add_u32 m0, s41, 94208
    s_add_u32 s58, s40, 819200
    buffer_load_dwordx4 v14, s[44:47], s58 offen lds
    s_add_u32 m0, s43, 98304
    s_add_u32 s58, s42, 851968
    buffer_load_dwordx4 v14, s[44:47], s58 offen lds
    s_waitcnt vmcnt(0)
    v_mov_b32 v9, 37
    ds_write_b32 v8, v9
    s_mul_i32 s60, s56, 22
    s_mul_i32 s61, s56, 20
    s_cmp_eq_u32 s56, 3
    s_subb_u32 s60, s60, 0
    s_cmp_eq_u32 s56, 3
    s_subb_u32 s61, s61, 0
    s_add_u32 s60, s60, 20
    s_cmp_ge_u32 s56, 2
    s_subb_u32 s60, s60, 0
    s_lshl_b32 s60, s60, 14
    s_lshl_b32 s58, s55, 7
    s_add_u32 s60, s60, s58
    s_lshl_b32 s61, s61, 11
    s_mov_b32 s59, 0x4000
LW_100:
    ds_read_b32 v9, v7
    s_waitcnt lgkmcnt(0)
    v_cmp_gt_u32 vcc, 34, v9
    s_cbranch_vccz LW_100_D
    s_sub_u32 s59, s59, 1
    s_cmp_lg_u32 s59, 0
    s_cbranch_scc1 LW_100
LW_100_D:
    s_add_u32 m0, s61, 0
    s_nop 0
    buffer_load_dwordx4 v14, s[44:47], s60 offen lds
    s_add_u32 s60, s60, 8192
    s_add_u32 m0, s61, 1024
    s_nop 0
    buffer_load_dwordx4 v14, s[44:47], s60 offen lds
    s_add_u32 s60, s60, 8192
    s_add_u32 m0, s61, 2048
    s_nop 0
    buffer_load_dwordx4 v14, s[44:47], s60 offen lds
    s_add_u32 s60, s60, 8192
    s_add_u32 m0, s61, 3072
    s_nop 0
    buffer_load_dwordx4 v14, s[44:47], s60 offen lds
    s_add_u32 s60, s60, 8192
    s_waitcnt vmcnt(0)
    v_mov_b32 v9, 38
    ds_write_b32 v8, v9
    s_waitcnt lgkmcnt(0)
    s_endpgm
MK_PF:
PF_B:
    s_cmp_eq_u32 s56, 0
    s_cbranch_scc0 PF_GO
    s_setprio 3
    s_mov_b32 s32, s26
    s_mov_b32 s33, s27
    s_mov_b32 s34, 0x100
    s_mov_b32 s35, 0x00020000
    s_add_u32 s36, s28, 0xe50000
    s_addc_u32 s37, s29, 0
    s_mov_b32 s38, 0x3000
    s_mov_b32 s39, 0x00020000
    s_add_u32 s48, s28, 0x2a00000
    s_addc_u32 s49, s29, 0
    s_mov_b32 s50, 0x8000
    s_mov_b32 s51, 0x00020000
    s_lshl_b32 s58, s2, 7
    v_lshlrev_b32 v0, 15, v1
    v_add_u32 v0, s58, v0
    s_lshr_b32 s63, s2, 3
    s_lshr_b32 s58, s2, 5
    s_add_u32 s63, s63, s58
    s_and_b32 s63, s63, 0
    s_lshl_b32 s63, s63, 15
    v_mov_b32 v4, 0
    s_mov_b32 s59, 0x4000
    s_mov_b64 exec, 1
    buffer_load_dword v2, v0, s[48:51], 0 offen
    buffer_load_dword v3, v4, s[36:39], 0 offen
    s_mov_b64 exec, -1
    s_sleep 16
    s_load_dwordx2 s[52:53], s[26:27], 0
    s_waitcnt lgkmcnt(0)
    s_cmp_lg_u32 s53, 0
    s_cbranch_scc1 PF_ND
    s_sleep 8
    s_load_dwordx2 s[52:53], s[26:27], 128
    s_waitcnt lgkmcnt(0)
    s_cmp_lg_u32 s53, 0
    s_cbranch_scc1 PF_ND
PF_NL:
    buffer_load_dwordx2 v[2:3], v4, s[32:35], 0 offen sc1
    s_waitcnt vmcnt(0)
    v_readfirstlane_b32 s52, v2
    v_readfirstlane_b32 s53, v3
    s_nop 0
    s_cmp_lg_u32 s53, 0
    s_cbranch_scc1 PF_ND
    s_sub_u32 s59, s59, 1
    s_cmp_lg_u32 s59, 0
    s_cbranch_scc1 PF_NL
PF_ND:
    s_waitcnt vmcnt(0)
    s_add_u32 s32, s28, 0xe50000
    s_addc_u32 s33, s29, 0
    s_mov_b32 s34, 0x3000
    s_mov_b32 s35, 0x00020000
    v_and_b32 v5, 3, v1
    v_lshlrev_b32 v5, 2, v5
    v_add_u32 v5, 163328, v5
    v_and_b32 v6, 3, v1
    v_lshlrev_b32 v6, 2, v6
    v_add_u32 v6, 163344, v6
    v_and_b32 v7, 7, v1
    v_lshlrev_b32 v7, 2, v7
    v_add_u32 v7, 163328, v7
    v_and_b32 v12, 1, v1
    v_lshlrev_b32 v12, 2, v12
    v_add_u32 v12, 163328, v12
    v_lshlrev_b32 v13, 7, v1
    v_add_u32 v16, 24576, v13
    s_lshl_b32 s58, s55, 12
    v_add_u32 v17, s58, v13
    s_and_b32 s58, s2, 31
    v_lshl_add_u32 v18, v1, 5, s58
    v_lshlrev_b32 v18, 7, v18
    s_and_b32 s58, s2, 7
    v_lshl_add_u32 v19, v1, 3, s58
    v_lshlrev_b32 v19, 7, v19
    v_and_b32 v2, 7, v1
    v_lshlrev_b32 v2, 4, v2
    v_lshlrev_b32 v3, 4, v1
    v_lshlrev_b32 v4, 3, v1
    v_add_u32 v4, 148480, v4
    s_lshr_b32 s60, s2, 4
    s_lshl_b32 s60, s60, 3
    s_and_b32 s61, s2, 7
    s_add_u32 s60, s60, s61
    s_lshl_b32 s60, s60, 1
    s_bfe_u32 s61, s2, 0x10003
    s_add_u32 s60, s60, s61
    s_lshr_b32 s61, s60, 4
    s_cmp_eq_u32 s61, 1
    s_cselect_b32 s62, 1.0, 0
    s_cmp_eq_u32 s61, 4
    s_cselect_b32 s62, 1.0, s62
    s_lshl_b32 s60, s60, 7
    v_mov_b32 v20, s52
    v_mov_b32 v21, s53
    s_cmp_lt_u32 s2, 32
    s_cbranch_scc0 SY_NG
    s_mov_b32 s59, 0x4000
LW_101:
    ds_read_b32 v9, v7
    s_waitcnt lgkmcnt(0)
    v_cmp_gt_u32 vcc, 3, v9
    s_cbranch_vccz LW_101_D
    s_sub_u32 s59, s59, 1
    s_cmp_lg_u32 s59, 0
    s_cbranch_scc1 LW_101
LW_101_D:
    ds_read_b128 v[24:27], v2 offset:0
    ds_read_b128 v[28:31], v2 offset:128
    ds_read_b128 v[32:35], v2 offset:256
    ds_read_b128 v[36:39], v2 offset:384
    ds_read_b128 v[40:43], v2 offset:512
    ds_read_b128 v[44:47], v2 offset:640
    ds_read_b128 v[48:51], v2 offset:768
    ds_read_b128 v[52:55], v2 offset:896
    s_waitcnt lgkmcnt(6)
    v_pk_add_f32 v[24:25], v[24:25], v[28:29]
    v_pk_add_f32 v[26:27], v[26:27], v[30:31]
    s_waitcnt lgkmcnt(4)
    v_pk_add_f32 v[32:33], v[32:33], v[36:37]
    v_pk_add_f32 v[34:35], v[34:35], v[38:39]
    s_waitcnt lgkmcnt(2)
    v_pk_add_f32 v[40:41], v[40:41], v[44:45]
    v_pk_add_f32 v[42:43], v[42:43], v[46:47]
    s_waitcnt lgkmcnt(0)
    v_pk_add_f32 v[48:49], v[48:49], v[52:53]
    v_pk_add_f32 v[50:51], v[50:51], v[54:55]
    v_pk_add_f32 v[24:25], v[24:25], v[32:33]
    v_pk_add_f32 v[26:27], v[26:27], v[34:35]
    v_pk_add_f32 v[40:41], v[40:41], v[48:49]
    v_pk_add_f32 v[42:43], v[42:43], v[50:51]
    v_pk_add_f32 v[24:25], v[24:25], v[40:41]
    v_pk_add_f32 v[26:27], v[26:27], v[42:43]
    v_cvt_pk_bf16_f32 v28, v24, v25
    v_cvt_pk_bf16_f32 v29, v26, v27
    v_lshlrev_b32 v24, 16, v28
    v_and_b32 v25, 0xffff0000, v28
    v_lshlrev_b32 v26, 16, v29
    v_and_b32 v27, 0xffff0000, v29
    v_add_f32 v24, s62, v24
    v_add_f32 v25, s62, v25
    v_add_f32 v26, s62, v26
    v_add_f32 v27, s62, v27
    v_cvt_pk_bf16_f32 v22, v24, v25
    v_cvt_pk_bf16_f32 v23, v26, v27
    s_mov_b64 exec, 0xff
    buffer_store_dwordx4 v[20:23], v2, s[32:35], s60 offen sc1
    s_mov_b64 exec, -1
    v_mov_b32 v9, 1
    ds_write_b32 v8, v9
SY_NG:
    s_cmp_lt_u32 s2, 192
    s_cbranch_scc1 SY_NZ
    s_mov_b32 s59, 0x4000
LW_102:
    ds_read_b32 v9, v12
    s_waitcnt lgkmcnt(0)
    v_cmp_gt_u32 vcc, 4, v9
    s_cbranch_vccz LW_102_D
    s_sub_u32 s59, s59, 1
    s_cmp_lg_u32 s59, 0
    s_cbranch_scc1 LW_102
LW_102_D:
    s_add_u32 s58, s52, 1
    s_waitcnt vmcnt(0)
    v_mov_b32 v10, s58
    v_mov_b32 v11, s53
    s_mov_b64 exec, 1
    buffer_store_dwordx2 v[10:11], v0, s[48:51], 0 offen sc1
    s_mov_b64 exec, -1
SY_NZ:
    s_mov_b64 s[36:37], -1
    s_mov_b64 s[38:39], -1
    s_mov_b64 s[40:41], -1
    s_mov_b64 s[42:43], -1
    s_mov_b32 s59, 0x4000
PU_103:
    s_mov_b64 exec, s[36:37]
    buffer_load_dwordx4 v[24:27], v3, s[32:35], 0 offen offset:0 sc1
    s_mov_b64 exec, s[38:39]
    buffer_load_dwordx4 v[28:31], v3, s[32:35], 0 offen offset:1024 sc1
    s_mov_b64 exec, s[40:41]
    buffer_load_dwordx4 v[32:35], v3, s[32:35], 0 offen offset:2048 sc1
    s_mov_b64 exec, s[42:43]
    buffer_load_dwordx4 v[36:39], v3, s[32:35], 0 offen offset:3072 sc1
    s_mov_b64 exec, s[36:37]
    s_waitcnt vmcnt(3)
    v_cmp_ne_u64 s[36:37], v[24:25], s[52:53]
    s_mov_b64 exec, s[38:39]
    s_waitcnt vmcnt(2)
    v_cmp_ne_u64 s[38:39], v[28:29], s[52:53]
    s_mov_b64 exec, s[40:41]
    s_waitcnt vmcnt(1)
    v_cmp_ne_u64 s[40:41], v[32:33], s[52:53]
    s_mov_b64 exec, s[42:43]
    s_waitcnt vmcnt(0)
    v_cmp_ne_u64 s[42:43], v[36:37], s[52:53]
    s_nop 1
    s_or_b64 s[30:31], s[36:37], s[38:39]
    s_or_b64 s[30:31], s[30:31], s[40:41]
    s_or_b64 s[30:31], s[30:31], s[42:43]
    s_cbranch_scc0 PU_103_D
    s_sub_u32 s59, s59, 1
    s_cmp_lg_u32 s59, 0
    s_cbranch_scc1 PU_103
PU_103_D:
    s_mov_b64 exec, -1
    ds_write_b64 v4, v[26:27] offset:0
    ds_write_b64 v4, v[30:31] offset:512
    ds_write_b64 v4, v[34:35] offset:1024
    ds_write_b64 v4, v[38:39] offset:1536
    v_mov_b32 v9, 2
    ds_write_b32 v8, v9
    s_add_u32 s58, s52, 1
    s_mov_b32 s59, 0x4000
    s_mov_b32 exec_lo, 0xffffffff
    s_mov_b32 exec_hi, 0x3
PL_104:
    buffer_load_dwordx2 v[10:11], v16, s[48:51], s63 offen sc1
    s_waitcnt vmcnt(0)
    v_subrev_u32 v10, s58, v10
    v_cmp_le_u32 vcc, 15, v10
    v_cmp_ne_u32 s[30:31], s53, v11
    s_nop 0
    s_or_b64 vcc, vcc, s[30:31]
    s_cbranch_vccz PL_104_D
    s_sleep 4
    s_sub_u32 s59, s59, 1
    s_cmp_lg_u32 s59, 0
    s_cbranch_scc1 PL_104
PL_104_D:
    s_mov_b64 exec, -1
    v_mov_b32 v9, 3
    ds_write_b32 v8, v9
    v_lshlrev_b32 v20, 4, v1
    v_lshrrev_b32 v2, 4, v1
    v_min_u32 v2, 2, v2
    v_and_b32 v3, 15, v1
    v_lshlrev_b32 v3, 4, v3
    v_lshl_add_u32 v23, v2, 8, v3
    v_add_u32 v23, 162560, v23
    v_lshl_add_u32 v21, v2, 12, v3
    v_cmp_eq_u32 vcc, 2, v2
    v_mov_b32 v3, 2048
    s_nop 0
    v_cndmask_b32 v3, 0, v3, vcc
    v_sub_u32 v21, v21, v3
    s_lshl_b32 s58, s55, 8
    v_add_u32 v21, s58, v21
    v_cmp_eq_u32 vcc, 1, v2
    s_nop 1
    v_cndmask_b32_e64 v14, 0, 1.0, vcc
    v_lshrrev_b32 v22, 2, v1
    v_lshlrev_b32 v22, 6, v22
    v_and_b32 v3, 1, v1
    v_lshl_add_u32 v22, v3, 4, v22
    v_bfe_u32 v3, v1, 1, 1
    v_lshl_add_u32 v22, v3, 3, v22
    v_add_u32 v22, 156672, v22
    v_mov_b32 v15, 163380
    s_add_u32 s32, s28, 0xea2000
    s_addc_u32 s33, s29, 0
    s_mov_b32 s34, 0x2000
    s_mov_b32 s35, 0x00020000
    s_mov_b32 s59, 0x4000
LW_105:
    ds_read_b32 v9, v15
    s_waitcnt lgkmcnt(0)
    v_cmp_gt_u32 vcc, 1, v9
    s_cbranch_vccz LW_105_D
    s_sub_u32 s59, s59, 1
    s_cmp_lg_u32 s59, 0
    s_cbranch_scc1 LW_105
LW_105_D:
    s_mov_b32 s59, 0x4000
LW_106:
    ds_read_b32 v9, v5
    s_waitcnt lgkmcnt(0)
    v_cmp_gt_u32 vcc, 19, v9
    s_cbranch_vccz LW_106_D
    s_sub_u32 s59, s59, 1
    s_cmp_lg_u32 s59, 0
    s_cbranch_scc1 LW_106
LW_106_D:
    s_add_u32 s58, s52, 2
    s_waitcnt vmcnt(0)
    v_mov_b32 v10, s58
    v_mov_b32 v11, s53
    s_mov_b64 exec, 1
    buffer_store_dwordx2 v[10:11], v0, s[48:51], 0 offen sc1
    s_mov_b64 exec, -1
    v_mov_b32 v9, 4
    ds_write_b32 v8, v9
    s_add_u32 s58, s52, 2
    s_mov_b32 s59, 0x4000
    s_mov_b32 exec_lo, 0xffffffff
    s_mov_b32 exec_hi, 0x0
PL_107:
    buffer_load_dwordx2 v[10:11], v17, s[48:51], s63 offen sc1
    s_waitcnt vmcnt(0)
    v_subrev_u32 v10, s58, v10
    v_cmp_le_u32 vcc, 14, v10
    v_cmp_ne_u32 s[30:31], s53, v11
    s_nop 0
    s_or_b64 vcc, vcc, s[30:31]
    s_cbranch_vccz PL_107_D
    s_sub_u32 s59, s59, 1
    s_cmp_lg_u32 s59, 0
    s_cbranch_scc1 PL_107
PL_107_D:
    s_mov_b64 exec, -1
    v_mov_b32 v9, 5
    ds_write_b32 v8, v9
    s_mov_b32 s59, 0x4000
LW_108:
    ds_read_b32 v9, v6
    s_waitcnt lgkmcnt(0)
    v_cmp_gt_u32 vcc, 19, v9
    s_cbranch_vccz LW_108_D
    s_sub_u32 s59, s59, 1
    s_cmp_lg_u32 s59, 0
    s_cbranch_scc1 LW_108
LW_108_D:
    s_add_u32 s58, s52, 3
    s_waitcnt vmcnt(0)
    v_mov_b32 v10, s58
    v_mov_b32 v11, s53
    s_mov_b64 exec, 1
    buffer_store_dwordx2 v[10:11], v0, s[48:51], 0 offen sc1
    s_mov_b64 exec, -1
    v_mov_b32 v9, 6
    ds_write_b32 v8, v9
    s_add_u32 s58, s52, 3
    s_mov_b32 s59, 0x4000
    s_mov_b32 exec_lo, 0xff
    s_mov_b32 exec_hi, 0x0
PL_109:
    buffer_load_dwordx2 v[10:11], v18, s[48:51], s63 offen sc1
    s_waitcnt vmcnt(0)
    v_subrev_u32 v10, s58, v10
    v_cmp_le_u32 vcc, 13, v10
    v_cmp_ne_u32 s[30:31], s53, v11
    s_nop 0
    s_or_b64 vcc, vcc, s[30:31]
    s_cbranch_vccz PL_109_D
    s_sub_u32 s59, s59, 1
    s_cmp_lg_u32 s59, 0
    s_cbranch_scc1 PL_109
PL_109_D:
    s_mov_b64 exec, -1
    v_mov_b32 v9, 7
    ds_write_b32 v8, v9
    buffer_load_dwordx4 v[24:27], v21, s[32:35], 0 offen sc1
    s_movk_i32 s58, 2048
    buffer_load_dwordx4 v[28:31], v20, s[32:35], s58 offen offset:0 sc1
    buffer_load_dwordx4 v[32:35], v20, s[32:35], s58 offen offset:1024 sc1
    buffer_load_dwordx4 v[36:39], v20, s[32:35], s58 offen offset:2048 sc1
    buffer_load_dwordx4 v[40:43], v20, s[32:35], s58 offen offset:3072 sc1
    s_waitcnt vmcnt(4)
    v_cvt_pk_bf16_f32 v2, v24, v25
    v_cvt_pk_bf16_f32 v3, v26, v27
    v_lshlrev_b32 v24, 16, v2
    v_and_b32 v25, 0xffff0000, v2
    v_lshlrev_b32 v26, 16, v3
    v_and_b32 v27, 0xffff0000, v3
    v_add_f32 v24, v14, v24
    v_add_f32 v25, v14, v25
    v_add_f32 v26, v14, v26
    v_add_f32 v27, v14, v27
    v_cvt_pk_bf16_f32 v2, v24, v25
    v_cvt_pk_bf16_f32 v3, v26, v27
    v_lshlrev_b32 v24, 16, v2
    v_and_b32 v25, 0xffff0000, v2
    v_lshlrev_b32 v26, 16, v3
    v_and_b32 v27, 0xffff0000, v3
    ds_write_b128 v23, v[24:27]
    v_mov_b32 v9, 8
    ds_write_b32 v8, v9
    s_waitcnt vmcnt(3)
    v_cvt_pk_bf16_f32 v2, v28, v29
    v_cvt_pk_bf16_f32 v3, v30, v31
    ds_write_b64 v22, v[2:3] offset:32
    s_waitcnt vmcnt(2)
    v_cvt_pk_bf16_f32 v2, v32, v33
    v_cvt_pk_bf16_f32 v3, v34, v35
    ds_write_b64 v22, v[2:3] offset:1056
    s_waitcnt vmcnt(1)
    v_cvt_pk_bf16_f32 v2, v36, v37
    v_cvt_pk_bf16_f32 v3, v38, v39
    v_lshlrev_b32 v36, 16, v2
    v_and_b32 v37, 0xffff0000, v2
    v_lshlrev_b32 v38, 16, v3
    v_and_b32 v39, 0xffff0000, v3
    v_add_f32 v36, 1.0, v36
    v_add_f32 v37, 1.0, v37
    v_add_f32 v38, 1.0, v38
    v_add_f32 v39, 1.0, v39
    v_cvt_pk_bf16_f32 v2, v36, v37
    v_cvt_pk_bf16_f32 v3, v38, v39
    ds_write_b64 v22, v[2:3] offset:0
    s_waitcnt vmcnt(0)
    v_cvt_pk_bf16_f32 v2, v40, v41
    v_cvt_pk_bf16_f32 v3, v42, v43
    v_lshlrev_b32 v40, 16, v2
    v_and_b32 v41, 0xffff0000, v2
    v_lshlrev_b32 v42, 16, v3
    v_and_b32 v43, 0xffff0000, v3
    v_add_f32 v40, 1.0, v40
    v_add_f32 v41, 1.0, v41
    v_add_f32 v42, 1.0, v42
    v_add_f32 v43, 1.0, v43
    v_cvt_pk_bf16_f32 v2, v40, v41
    v_cvt_pk_bf16_f32 v3, v42, v43
    ds_write_b64 v22, v[2:3] offset:1024
    v_mov_b32 v9, 9
    ds_write_b32 v8, v9
    s_add_u32 s32, s28, 0x2800000
    s_addc_u32 s33, s29, 0
    s_mov_b32 s34, 0x20000
    s_mov_b32 s35, 0x00020000
    v_and_b32 v2, 31, v1
    v_lshlrev_b32 v2, 3, v2
    v_lshrrev_b32 v3, 5, v1
    v_lshl_add_u32 v4, v3, 11, v2
    v_lshl_add_u32 v2, v3, 10, v2
    v_add_u32 v2, 160512, v2
    s_lshl_b32 s60, s54, 12
    s_lshl_b32 s58, s55, 8
    s_add_u32 s60, s60, s58
    s_mov_b32 s59, 0x4000
LW_110:
    ds_read_b32 v9, v7
    s_waitcnt lgkmcnt(0)
    v_cmp_gt_u32 vcc, 23, v9
    s_cbranch_vccz LW_110_D
    s_sub_u32 s59, s59, 1
    s_cmp_lg_u32 s59, 0
    s_cbranch_scc1 LW_110
LW_110_D:
    ds_read_b64 v[24:25], v2 offset:0
    ds_read_b64 v[26:27], v2 offset:256
    ds_read_b64 v[28:29], v2 offset:512
    ds_read_b64 v[30:31], v2 offset:768
    s_waitcnt lgkmcnt(0)
    v_pk_add_f32 v[24:25], v[24:25], v[26:27]
    v_pk_add_f32 v[28:29], v[28:29], v[30:31]
    v_pk_add_f32 v[24:25], v[24:25], v[28:29]
    buffer_store_dwordx2 v[24:25], v4, s[32:35], s60 offen sc1
    s_mov_b32 s59, 0x4000
LW_111:
    ds_read_b32 v9, v7
    s_waitcnt lgkmcnt(0)
    v_cmp_gt_u32 vcc, 24, v9
    s_cbranch_vccz LW_111_D
    s_sub_u32 s59, s59, 1
    s_cmp_lg_u32 s59, 0
    s_cbranch_scc1 LW_111
LW_111_D:
    s_waitcnt vmcnt(0)
    s_add_u32 s58, s52, 4
    s_waitcnt vmcnt(0)
    v_mov_b32 v10, s58
    v_mov_b32 v11, s53
    s_mov_b64 exec, 1
    buffer_store_dwordx2 v[10:11], v0, s[48:51], 0 offen sc1
    s_mov_b64 exec, -1
    v_mov_b32 v9, 10
    ds_write_b32 v8, v9
    s_add_u32 s58, s52, 4
    s_mov_b32 s59, 0x4000
    s_mov_b32 exec_lo, 0xffffffff
    s_mov_b32 exec_hi, 0x0
PL_112:
    buffer_load_dwordx2 v[10:11], v19, s[48:51], s63 offen sc1
    s_waitcnt vmcnt(0)
    v_subrev_u32 v10, s58, v10
    v_cmp_le_u32 vcc, 12, v10
    v_cmp_ne_u32 s[30:31], s53, v11
    s_nop 0
    s_or_b64 vcc, vcc, s[30:31]
    s_cbranch_vccz PL_112_D
    s_sub_u32 s59, s59, 1
    s_cmp_lg_u32 s59, 0
    s_cbranch_scc1 PL_112
PL_112_D:
    s_mov_b64 exec, -1
    v_mov_b32 v9, 11
    ds_write_b32 v8, v9
    s_mov_b32 s59, 0x4000
LW_113:
    ds_read_b32 v9, v7
    s_waitcnt lgkmcnt(0)
    v_cmp_gt_u32 vcc, 33, v9
    s_cbranch_vccz LW_113_D
    s_sub_u32 s59, s59, 1
    s_cmp_lg_u32 s59, 0
    s_cbranch_scc1 LW_113
LW_113_D:
    s_add_u32 s58, s52, 5
    s_waitcnt vmcnt(0)
    v_mov_b32 v10, s58
    v_mov_b32 v11, s53
    s_mov_b64 exec, 1
    buffer_store_dwordx2 v[10:11], v0, s[48:51], 0 offen sc1
    s_mov_b64 exec, -1
    v_mov_b32 v9, 12
    ds_write_b32 v8, v9
    s_add_u32 s58, s52, 5
    s_mov_b32 s59, 0x4000
    s_mov_b32 exec_lo, 0xffffffff
    s_mov_b32 exec_hi, 0x0
PL_114:
    buffer_load_dwordx2 v[10:11], v19, s[48:51], s63 offen sc1
    s_waitcnt vmcnt(0)
    v_subrev_u32 v10, s58, v10
    v_cmp_le_u32 vcc, 11, v10
    v_cmp_ne_u32 s[30:31], s53, v11
    s_nop 0
    s_or_b64 vcc, vcc, s[30:31]
    s_cbranch_vccz PL_114_D
    s_sub_u32 s59, s59, 1
    s_cmp_lg_u32 s59, 0
    s_cbranch_scc1 PL_114
PL_114_D:
    s_mov_b64 exec, -1
    v_mov_b32 v9, 13
    ds_write_b32 v8, v9
    s_waitcnt vmcnt(0) lgkmcnt(0)
    s_endpgm
PF_GO:
    s_lshr_b32 s40, s2, 3
    s_and_b32 s58, s56, 1
    s_lshl_b32 s58, s58, 5
    s_add_u32 s40, s40, s58
    s_cmp_eq_u32 s56, 1
    s_cbranch_scc0 PF_NG
    s_mov_b32 s32, s20
    s_mov_b32 s33, s21
    s_mov_b32 s34, 0x400
    s_mov_b32 s35, 0x00020000
    s_mov_b32 s36, s22
    s_mov_b32 s37, s23
    s_mov_b32 s38, 0x300000
    s_mov_b32 s39, 0x00020000
    s_add_u32 s48, s28, 0xea2000
    s_addc_u32 s49, s29, 0
    s_mov_b32 s50, 0x2000
    s_mov_b32 s51, 0x00020000
    v_lshrrev_b32 v2, 3, v1
    v_and_b32 v3, 7, v1
    v_lshlrev_b32 v6, 4, v2
    v_mul_u32_u24 v7, 49152, v2
    v_lshl_add_u32 v7, v3, 4, v7
    s_and_b32 s62, s2, 7
    s_lshl_b32 s61, s62, 7
    s_mul_i32 s62, s62, 393216
    s_lshr_b32 s63, s2, 3
    s_lshl_b32 s60, s63, 7
    s_add_u32 s62, s62, s60
    s_lshl_b32 s63, s63, 8
    v_mov_b32 v10, 163376
    s_mov_b32 s59, 0x4000
LW_115:
    ds_read_b32 v9, v10
    s_waitcnt lgkmcnt(0)
    v_cmp_gt_u32 vcc, 2, v9
    s_cbranch_vccz LW_115_D
    s_sub_u32 s59, s59, 1
    s_cmp_lg_u32 s59, 0
    s_cbranch_scc1 LW_115
LW_115_D:
    buffer_load_dwordx4 v[16:19], v6, s[32:35], s61 offen
    buffer_load_dwordx4 v[32:35], v7, s[36:39], s62 offen offset:2048
    s_add_u32 s62, s62, 6144
    buffer_load_dwordx4 v[36:39], v7, s[36:39], s62 offen offset:2048
    s_add_u32 s62, s62, 6144
    buffer_load_dwordx4 v[40:43], v7, s[36:39], s62 offen offset:2048
    s_add_u32 s62, s62, 6144
    buffer_load_dwordx4 v[44:47], v7, s[36:39], s62 offen offset:2048
    s_add_u32 s62, s62, 6144
    buffer_load_dwordx4 v[48:51], v7, s[36:39], s62 offen offset:2048
    s_add_u32 s62, s62, 6144
    buffer_load_dwordx4 v[52:55], v7, s[36:39], s62 offen offset:2048
    s_add_u32 s62, s62, 6144
    buffer_load_dwordx4 v[56:59], v7, s[36:39], s62 offen offset:2048
    s_add_u32 s62, s62, 6144
    buffer_load_dwordx4 v[60:63], v7, s[36:39], s62 offen offset:2048
    s_waitcnt vmcnt(0)
    v_lshlrev_b32 v20, 16, v16
    v_and_b32 v21, 0xffff0000, v16
    v_lshlrev_b32 v22, 16, v17
    v_and_b32 v23, 0xffff0000, v17
    v_lshlrev_b32 v24, 16, v18
    v_and_b32 v25, 0xffff0000, v18
    v_lshlrev_b32 v26, 16, v19
    v_and_b32 v27, 0xffff0000, v19
    s_mov_b32 s58, 0xbfb8aa3b
    v_mul_f32 v64, s58, v20
    v_mul_f32 v65, s58, v21
    v_mul_f32 v66, s58, v22
    v_mul_f32 v67, s58, v23
    v_mul_f32 v68, s58, v24
    v_mul_f32 v69, s58, v25
    v_mul_f32 v70, s58, v26
    v_mul_f32 v71, s58, v27
    v_exp_f32 v64, v64
    v_exp_f32 v65, v65
    v_exp_f32 v66, v66
    v_exp_f32 v67, v67
    v_exp_f32 v68, v68
    v_exp_f32 v69, v69
    v_exp_f32 v70, v70
    v_exp_f32 v71, v71
    v_add_f32 v64, 1.0, v64
    v_add_f32 v65, 1.0, v65
    v_add_f32 v66, 1.0, v66
    v_add_f32 v67, 1.0, v67
    v_add_f32 v68, 1.0, v68
    v_add_f32 v69, 1.0, v69
    v_add_f32 v70, 1.0, v70
    v_add_f32 v71, 1.0, v71
    v_rcp_f32 v64, v64
    v_rcp_f32 v65, v65
    v_rcp_f32 v66, v66
    v_rcp_f32 v67, v67
    v_rcp_f32 v68, v68
    v_rcp_f32 v69, v69
    v_rcp_f32 v70, v70
    v_rcp_f32 v71, v71
    v_mul_f32 v20, v20, v64
    v_mul_f32 v21, v21, v65
    v_mul_f32 v22, v22, v66
    v_mul_f32 v23, v23, v67
    v_mul_f32 v24, v24, v68
    v_mul_f32 v25, v25, v69
    v_mul_f32 v26, v26, v70
    v_mul_f32 v27, v27, v71
    v_cvt_pk_bf16_f32 v64, v20, v21
    v_cvt_pk_bf16_f32 v65, v22, v23
    v_cvt_pk_bf16_f32 v66, v24, v25
    v_cvt_pk_bf16_f32 v67, v26, v27
    v_lshlrev_b32 v20, 16, v64
    v_and_b32 v21, 0xffff0000, v64
    v_lshlrev_b32 v22, 16, v65
    v_and_b32 v23, 0xffff0000, v65
    v_lshlrev_b32 v24, 16, v66
    v_and_b32 v25, 0xffff0000, v66
    v_lshlrev_b32 v26, 16, v67
    v_and_b32 v27, 0xffff0000, v67
    v_lshlrev_b32 v64, 16, v32
    v_and_b32 v65, 0xffff0000, v32
    v_lshlrev_b32 v66, 16, v33
    v_and_b32 v67, 0xffff0000, v33
    v_lshlrev_b32 v68, 16, v34
    v_and_b32 v69, 0xffff0000, v34
    v_lshlrev_b32 v70, 16, v35
    v_and_b32 v71, 0xffff0000, v35
    v_pk_mul_f32 v[72:73], v[64:65], v[20:21] op_sel_hi:[1,0]
    v_pk_mul_f32 v[74:75], v[66:67], v[20:21] op_sel_hi:[1,0]
    v_pk_mul_f32 v[76:77], v[68:69], v[20:21] op_sel_hi:[1,0]
    v_pk_mul_f32 v[78:79], v[70:71], v[20:21] op_sel_hi:[1,0]
    v_lshlrev_b32 v64, 16, v36
    v_and_b32 v65, 0xffff0000, v36
    v_lshlrev_b32 v66, 16, v37
    v_and_b32 v67, 0xffff0000, v37
    v_lshlrev_b32 v68, 16, v38
    v_and_b32 v69, 0xffff0000, v38
    v_lshlrev_b32 v70, 16, v39
    v_and_b32 v71, 0xffff0000, v39
    v_pk_fma_f32 v[72:73], v[64:65], v[20:21], v[72:73] op_sel:[0,1,0] op_sel_hi:[1,1,1]
    v_pk_fma_f32 v[74:75], v[66:67], v[20:21], v[74:75] op_sel:[0,1,0] op_sel_hi:[1,1,1]
    v_pk_fma_f32 v[76:77], v[68:69], v[20:21], v[76:77] op_sel:[0,1,0] op_sel_hi:[1,1,1]
    v_pk_fma_f32 v[78:79], v[70:71], v[20:21], v[78:79] op_sel:[0,1,0] op_sel_hi:[1,1,1]
    v_lshlrev_b32 v64, 16, v40
    v_and_b32 v65, 0xffff0000, v40
    v_lshlrev_b32 v66, 16, v41
    v_and_b32 v67, 0xffff0000, v41
    v_lshlrev_b32 v68, 16, v42
    v_and_b32 v69, 0xffff0000, v42
    v_lshlrev_b32 v70, 16, v43
    v_and_b32 v71, 0xffff0000, v43
    v_pk_fma_f32 v[72:73], v[64:65], v[22:23], v[72:73] op_sel_hi:[1,0,1]
    v_pk_fma_f32 v[74:75], v[66:67], v[22:23], v[74:75] op_sel_hi:[1,0,1]
    v_pk_fma_f32 v[76:77], v[68:69], v[22:23], v[76:77] op_sel_hi:[1,0,1]
    v_pk_fma_f32 v[78:79], v[70:71], v[22:23], v[78:79] op_sel_hi:[1,0,1]
    v_lshlrev_b32 v64, 16, v44
    v_and_b32 v65, 0xffff0000, v44
    v_lshlrev_b32 v66, 16, v45
    v_and_b32 v67, 0xffff0000, v45
    v_lshlrev_b32 v68, 16, v46
    v_and_b32 v69, 0xffff0000, v46
    v_lshlrev_b32 v70, 16, v47
    v_and_b32 v71, 0xffff0000, v47
    v_pk_fma_f32 v[72:73], v[64:65], v[22:23], v[72:73] op_sel:[0,1,0] op_sel_hi:[1,1,1]
    v_pk_fma_f32 v[74:75], v[66:67], v[22:23], v[74:75] op_sel:[0,1,0] op_sel_hi:[1,1,1]
    v_pk_fma_f32 v[76:77], v[68:69], v[22:23], v[76:77] op_sel:[0,1,0] op_sel_hi:[1,1,1]
    v_pk_fma_f32 v[78:79], v[70:71], v[22:23], v[78:79] op_sel:[0,1,0] op_sel_hi:[1,1,1]
    v_lshlrev_b32 v64, 16, v48
    v_and_b32 v65, 0xffff0000, v48
    v_lshlrev_b32 v66, 16, v49
    v_and_b32 v67, 0xffff0000, v49
    v_lshlrev_b32 v68, 16, v50
    v_and_b32 v69, 0xffff0000, v50
    v_lshlrev_b32 v70, 16, v51
    v_and_b32 v71, 0xffff0000, v51
    v_pk_fma_f32 v[72:73], v[64:65], v[24:25], v[72:73] op_sel_hi:[1,0,1]
    v_pk_fma_f32 v[74:75], v[66:67], v[24:25], v[74:75] op_sel_hi:[1,0,1]
    v_pk_fma_f32 v[76:77], v[68:69], v[24:25], v[76:77] op_sel_hi:[1,0,1]
    v_pk_fma_f32 v[78:79], v[70:71], v[24:25], v[78:79] op_sel_hi:[1,0,1]
    v_lshlrev_b32 v64, 16, v52
    v_and_b32 v65, 0xffff0000, v52
    v_lshlrev_b32 v66, 16, v53
    v_and_b32 v67, 0xffff0000, v53
    v_lshlrev_b32 v68, 16, v54
    v_and_b32 v69, 0xffff0000, v54
    v_lshlrev_b32 v70, 16, v55
    v_and_b32 v71, 0xffff0000, v55
    v_pk_fma_f32 v[72:73], v[64:65], v[24:25], v[72:73] op_sel:[0,1,0] op_sel_hi:[1,1,1]
    v_pk_fma_f32 v[74:75], v[66:67], v[24:25], v[74:75] op_sel:[0,1,0] op_sel_hi:[1,1,1]
    v_pk_fma_f32 v[76:77], v[68:69], v[24:25], v[76:77] op_sel:[0,1,0] op_sel_hi:[1,1,1]
    v_pk_fma_f32 v[78:79], v[70:71], v[24:25], v[78:79] op_sel:[0,1,0] op_sel_hi:[1,1,1]
    v_lshlrev_b32 v64, 16, v56
    v_and_b32 v65, 0xffff0000, v56
    v_lshlrev_b32 v66, 16, v57
    v_and_b32 v67, 0xffff0000, v57
    v_lshlrev_b32 v68, 16, v58
    v_and_b32 v69, 0xffff0000, v58
    v_lshlrev_b32 v70, 16, v59
    v_and_b32 v71, 0xffff0000, v59
    v_pk_fma_f32 v[72:73], v[64:65], v[26:27], v[72:73] op_sel_hi:[1,0,1]
    v_pk_fma_f32 v[74:75], v[66:67], v[26:27], v[74:75] op_sel_hi:[1,0,1]
    v_pk_fma_f32 v[76:77], v[68:69], v[26:27], v[76:77] op_sel_hi:[1,0,1]
    v_pk_fma_f32 v[78:79], v[70:71], v[26:27], v[78:79] op_sel_hi:[1,0,1]
    v_lshlrev_b32 v64, 16, v60
    v_and_b32 v65, 0xffff0000, v60
    v_lshlrev_b32 v66, 16, v61
    v_and_b32 v67, 0xffff0000, v61
    v_lshlrev_b32 v68, 16, v62
    v_and_b32 v69, 0xffff0000, v62
    v_lshlrev_b32 v70, 16, v63
    v_and_b32 v71, 0xffff0000, v63
    v_pk_fma_f32 v[72:73], v[64:65], v[26:27], v[72:73] op_sel:[0,1,0] op_sel_hi:[1,1,1]
    v_pk_fma_f32 v[74:75], v[66:67], v[26:27], v[74:75] op_sel:[0,1,0] op_sel_hi:[1,1,1]
    v_pk_fma_f32 v[76:77], v[68:69], v[26:27], v[76:77] op_sel:[0,1,0] op_sel_hi:[1,1,1]
    v_pk_fma_f32 v[78:79], v[70:71], v[26:27], v[78:79] op_sel:[0,1,0] op_sel_hi:[1,1,1]
    s_nop 0
    v_permlane32_swap_b32 v72, v76
    v_permlane32_swap_b32 v73, v77
    v_permlane32_swap_b32 v74, v78
    v_permlane32_swap_b32 v75, v79
    v_pk_add_f32 v[72:73], v[72:73], v[76:77]
    v_pk_add_f32 v[74:75], v[74:75], v[78:79]
    s_nop 1
    v_permlane16_swap_b32 v72, v74
    v_permlane16_swap_b32 v73, v75
    v_pk_add_f32 v[72:73], v[72:73], v[74:75]
    s_nop 1
    v_add_f32_dpp v74, v72, v72 row_ror:8 row_mask:0xf bank_mask:0xf
    v_add_f32_dpp v75, v73, v73 row_ror:8 row_mask:0xf bank_mask:0xf
    v_mov_b32 v72, v74
    v_mov_b32 v73, v75
    v_lshlrev_b32 v6, 2, v2
    v_lshl_add_u32 v6, v3, 5, v6
    v_and_b32 v2, 1, v2
    v_cmp_eq_u32 vcc, 0, v2
    s_nop 1
    v_cndmask_b32 v72, v73, v72, vcc
    v_mov_b32 v10, 163376
    s_mov_b32 s59, 0x4000
LW_116:
    ds_read_b32 v9, v10
    s_waitcnt lgkmcnt(0)
    v_cmp_gt_u32 vcc, 3, v9
    s_cbranch_vccz LW_116_D
    s_sub_u32 s59, s59, 1
    s_cmp_lg_u32 s59, 0
    s_cbranch_scc1 LW_116
LW_116_D:
    buffer_atomic_add_f32 v72, v6, s[48:51], s63 offen sc1
    s_waitcnt vmcnt(0)
    v_mov_b32 v9, 1
    ds_write_b32 v8, v9
    s_mov_b32 s32, s14
    s_mov_b32 s33, s15
    s_mov_b32 s34, 0x158000
    s_mov_b32 s35, 0x00020000
    s_mov_b32 s36, s16
    s_mov_b32 s37, s17
    s_mov_b32 s38, 0x158000
    s_mov_b32 s39, 0x00020000
    s_mov_b32 s48, s18
    s_mov_b32 s49, s19
    s_mov_b32 s50, 0x158000
    s_mov_b32 s51, 0x00020000
    v_min_u32 v2, 42, v1
    v_lshlrev_b32 v2, 7, v2
    s_mul_i32 s62, s2, 5504
    buffer_load_dword v4, v2, s[32:35], s62 offen
    buffer_load_dword v5, v2, s[36:39], s62 offen
    buffer_load_dword v6, v2, s[48:51], s62 offen
    s_branch PF_END
PF_NG:
    s_lshr_b32 s58, s40, 3
    s_mul_i32 s60, s58, 3072
    s_and_b32 s58, s40, 7
    s_lshl_b32 s58, s58, 7
    s_add_u32 s60, s60, s58
    s_add_u32 s60, s60, 591872
    s_mov_b32 s61, 40
PF_117:
    s_min_u32 s60, s60, 0x17ff80
    s_load_dwordx2 s[44:45], s[6:7], s60 offset:60
    s_waitcnt lgkmcnt(13)
    s_add_u32 s60, s60, 24576
    s_sub_u32 s61, s61, 1
    s_cmp_lg_u32 s61, 0
    s_cbranch_scc1 PF_117
    s_lshl_b32 s60, s40, 7
    s_mov_b32 s61, 64
PF_118:
    s_min_u32 s60, s60, 0x7ff80
    s_load_dwordx2 s[44:45], s[10:11], s60 offset:60
    s_waitcnt lgkmcnt(13)
    s_add_u32 s60, s60, 8192
    s_sub_u32 s61, s61, 1
    s_cmp_lg_u32 s61, 0
    s_cbranch_scc1 PF_118
    s_waitcnt lgkmcnt(0)
    s_lshl_b32 s60, s40, 7
    s_mov_b32 s61, 172
PF_119:
    s_min_u32 s60, s60, 0x157f80
    s_load_dwordx2 s[44:45], s[14:15], s60 offset:60
    s_waitcnt lgkmcnt(13)
    s_load_dwordx2 s[46:47], s[16:17], s60 offset:60
    s_waitcnt lgkmcnt(13)
    s_add_u32 s60, s60, 8192
    s_sub_u32 s61, s61, 1
    s_cmp_lg_u32 s61, 0
    s_cbranch_scc1 PF_119
    s_lshl_b32 s60, s40, 7
    s_mov_b32 s61, 172
PF_120:
    s_min_u32 s60, s60, 0x157f80
    s_load_dwordx2 s[44:45], s[18:19], s60 offset:60
    s_waitcnt lgkmcnt(13)
    s_add_u32 s60, s60, 8192
    s_sub_u32 s61, s61, 1
    s_cmp_lg_u32 s61, 0
    s_cbranch_scc1 PF_120
PF_END:
    s_waitcnt lgkmcnt(0)
MK_END:
    s_endpgm
.section .rodata,"a"
.p2align 6
.amdhsa_kernel mega_kernel
  .amdhsa_next_free_vgpr 128
  .amdhsa_next_free_sgpr 64
  .amdhsa_accum_offset 128
  .amdhsa_group_segment_fixed_size 0
  .amdhsa_kernarg_size 104
  .amdhsa_user_sgpr_count 2
  .amdhsa_user_sgpr_kernarg_segment_ptr 1
  .amdhsa_system_sgpr_workgroup_id_x 1
.end_amdhsa_kernel
```
